```python
import torch

def _softmax(x, axis=-1):
    return torch.softmax(x, dim=axis)

def _gelu(x):
    return torch.nn.functional.gelu(x, approximate='tanh')

def _silu(x):
    return torch.nn.functional.silu(x)

def _sigmoid(x):
    return torch.sigmoid(x)

def _layernorm(x, axis=-1, eps=1e-05):
    m = x.mean(dim=axis, keepdim=True)
    v = x.var(dim=axis, keepdim=True, unbiased=False)
    return (x - m) / torch.sqrt(v + eps)

def _scatter_add(tgt, idx, src, axis=0):
    return tgt.clone().index_add_(axis, idx, src)

def _segment_sum(src, seg, n):
    out = torch.zeros((n,) + src.shape[1:], dtype=src.dtype)
    return out.index_add_(0, seg, src)

def _pad(x, pw):
    flat = tuple((v for pair in reversed(pw) for v in pair))
    return torch.nn.functional.pad(x, flat)
kernel_name = 'adaLN_cond__ssm_conv_s4d__geglu_ffn__prompt'

def setup_inputs():

    _w = lambda a: (lambda t: t.to(torch.bfloat16) if t.is_floating_point() else t)(torch.as_tensor(a))

    def _A_setup():
        Bsz, L, D, N = (1, 2048, 512, 128)
        return {'u': _w((lambda *s: torch.randn(*s, dtype=torch.bfloat16) * 0.05)(Bsz, L, D)), 'log_A_real': _w((lambda *s: torch.randn(*s, dtype=torch.bfloat16) * 3.2)(D, N) * 0.5), 'A_imag': _w((lambda *s: torch.randn(*s, dtype=torch.bfloat16) * 0.05)(D, N) * 3.14), 'C_real': _w((lambda *s: torch.randn(*s, dtype=torch.bfloat16) * 0.4)(D, N) / N ** 0.5), 'C_imag': _w((lambda *s: torch.randn(*s, dtype=torch.bfloat16) * 0.4)(D, N) / N ** 0.5), 'log_dt': _w((lambda *s: torch.randn(*s, dtype=torch.bfloat16) * 0.05)(D) * 0.5 - 4.0), 'D_skip': _w((lambda *s: torch.randn(*s, dtype=torch.bfloat16) * 0.1)(D))}
    _A_in = _A_setup()

    def _B_setup():
        B, S, D, F = (1, 2048, 512, 1376)
        return {'x': _w((lambda *s: torch.randn(*s, dtype=torch.bfloat16) * 0.05)(B, S, D)), 'w_gate': _w((lambda *s: torch.randn(*s, dtype=torch.bfloat16) * 0.05)(D, F)), 'w_up': _w((lambda *s: torch.randn(*s, dtype=torch.bfloat16) * 0.05)(D, F)), 'w_down': _w((lambda *s: torch.randn(*s, dtype=torch.bfloat16) * 0.05)(F, D))}
    _B_in = _B_setup()
    return {'A_u': _A_in['u'], 'A_log_A_real': _A_in['log_A_real'], 'A_A_imag': _A_in['A_imag'], 'A_C_real': _A_in['C_real'], 'A_C_imag': _A_in['C_imag'], 'A_log_dt': _A_in['log_dt'], 'A_D_skip': _A_in['D_skip'], 'B_x': _B_in['x'], 'B_w_gate': _B_in['w_gate'], 'B_w_up': _B_in['w_up'], 'B_w_down': _B_in['w_down'], 'c': _w((lambda *s: torch.randn(*s, dtype=torch.bfloat16) * 0.2)(1, 512) * 8.0), 'w_mod': _w((lambda *s: torch.randn(*s, dtype=torch.bfloat16) * 0.2)(512, 6 * 512) * 512 ** (-0.5) * 8.0)}

def reference(A_u, A_log_A_real, A_A_imag, A_C_real, A_C_imag, A_log_dt, A_D_skip, B_x, B_w_gate, B_w_up, B_w_down, c, w_mod):

    def _A_ref(u, log_A_real, A_imag, C_real, C_imag, log_dt, D_skip):
        L = u.shape[1]
        dt = torch.exp(log_dt)
        A = -torch.exp(log_A_real) + 1j * A_imag
        C = (C_real + 1j * C_imag) * dt[:, None]
        pos = (lambda x, dt: x.to(dt))(torch.arange(L), log_dt.dtype)
        P = torch.exp((A * dt[:, None])[:, :, None] * pos[None, None, :])
        K = 2.0 * torch.einsum('dn,dnl->dl', C, P).real
        L2 = 2 * L
        u_t = (lambda x, *d: x.permute(*d))(u, 0, 2, 1)
        Kf = (lambda x, *a, **k: torch.fft.rfft(x.float(), *a, **k))(K, L2)
        Uf = (lambda x, *a, **k: torch.fft.rfft(x.float(), *a, **k))(u_t, L2)
        y = (lambda x, *a, **k: torch.fft.irfft(x, *a, **k).to(torch.bfloat16))(Uf * Kf[None, :, :], L2)[:, :, :L]
        y = (lambda x, *d: x.permute(*d))(y, 0, 2, 1)
        return y + u * D_skip[None, None, :]

    def _B_ref(x, w_gate, w_up, w_down):
        return _gelu(x @ w_gate) * (x @ w_up) @ w_down
    x = A_u
    mod = (_silu(c) @ w_mod).reshape(c.shape[0], 6, 1, -1)
    sa, ca, ga, sb, cb, gb = (mod[:, 0].clone(), mod[:, 1].clone(), mod[:, 2].clone(), mod[:, 3].clone(), mod[:, 4].clone(), mod[:, 5].clone())
    h = _layernorm(x, axis=-1) * (1 + ca) + sa
    x = x + ga * _A_ref(h, A_log_A_real, A_A_imag, A_C_real, A_C_imag, A_log_dt, A_D_skip)
    h = _layernorm(x, axis=-1) * (1 + cb) + sb
    x = x + gb * _B_ref(h, B_w_gate, B_w_up, B_w_down)
    return x
```

```asm
; @launch grid=(256,1,1) block=(256,1,1) lds=158208
.amdgcn_target "amdgcn-amd-amdhsa--gfx950"
.text
.globl adaLN_cond__ssm_conv_s4d__geglu_ffn__prompt_kernel
.p2align 8
.type adaLN_cond__ssm_conv_s4d__geglu_ffn__prompt_kernel,@function
adaLN_cond__ssm_conv_s4d__geglu_ffn__prompt_kernel:
    s_cmp_ge_u32 s2, 256
    s_cbranch_scc1 L_end
    s_load_dwordx16 s[16:31], s[0:1], 0
    s_load_dwordx16 s[32:47], s[0:1], 64
    s_memrealtime s[100:101]
    s_getpc_b64 s[14:15]
L_pc:
    s_sub_u32 s14, s14, L_pc-adaLN_cond__ssm_conv_s4d__geglu_ffn__prompt_kernel
    s_subb_u32 s15, s15, 0
    s_lshr_b32 s4, s2, 3
    s_lshl_b32 s4, s4, 12
    s_cmp_gt_u32 s4, L_codeend-adaLN_cond__ssm_conv_s4d__geglu_ffn__prompt_kernel-4096
    s_cbranch_scc1 Lskip_1
    v_lshl_add_u32 v1, v0, 4, s4
    global_load_dwordx4 v[4:7], v1, s[14:15]
Lskip_1:
    v_and_b32 v1, 63, v0
    v_lshrrev_b32 v2, 6, v0
    s_and_b32 s73, s2, 7
    s_lshr_b32 s74, s2, 3
    v_readfirstlane_b32 s72, v2
    s_lshl_b32 s75, s73, 6
    s_lshl_b32 s4, s74, 1
    s_add_u32 s75, s75, s4
    s_lshr_b32 s76, s72, 1
    s_and_b32 s77, s72, 1
    s_lshl_b32 s4, s73, 2
    s_lshr_b32 s4, 0x54ff3210, s4
    s_and_b32 s4, s4, 15
    s_mul_i32 s99, s74, 6
    s_add_u32 s99, s99, s4
    s_cmp_eq_u32 s4, 15
    s_cselect_b32 s99, 255, s99
    s_mov_b32 s84, 8192
    s_mov_b32 s82, 1024
    s_mov_b32 s85, 6144
    s_mov_b32 s86, 12288
    s_mov_b32 s87, 18432
    s_add_u32 s4, s75, s76
    s_lshl_b32 s4, s4, 8
    s_lshl_b32 s5, s77, 7
    s_add_u32 s4, s4, s5
    v_lshl_add_u32 v2, v1, 1, s4
    v_lshlrev_b32 v3, 4, v1
    s_lshr_b32 s90, s74, 3
    s_lshl_b32 s4, s73, 2
    s_add_u32 s90, s90, s4
    s_and_b32 s91, s74, 7
    s_lshl_b32 s4, s90, 6
    s_lshl_b32 s5, s72, 4
    s_add_u32 s4, s4, s5
    s_lshl_b32 s4, s4, 10
    s_lshl_b32 s5, s91, 7
    s_add_u32 s4, s4, s5
    v_lshrrev_b32 v8, 5, v1
    v_lshlrev_b32 v8, 1, v8
    v_and_b32 v9, 7, v1
    v_xor_b32 v8, v8, v9
    v_lshrrev_b32 v10, 3, v1
    v_lshlrev_b32 v10, 10, v10
    v_lshl_add_u32 v8, v8, 4, v10
    v_add_u32 v12, s4, v8
    v_xor_b32 v13, 64, v12
    s_and_b32 s4, s99, 3
    s_lshl_b32 s4, s4, 5
    v_lshrrev_b32 v8, 3, v0
    v_add_u32 v8, s4, v8
    v_lshlrev_b32 v15, 3, v8
    v_mul_u32_u24 v8, 24576, v8
    v_lshl_add_u32 v8, v9, 4, v8
    s_lshr_b32 s4, s99, 2
    s_lshl_b32 s4, s4, 7
    v_add_u32 v14, s4, v8
    s_cmp_ge_u32 s99, 192
    s_cselect_b32 s4, 0x7ff00000, 0
    v_or_b32 v14, s4, v14
    s_waitcnt lgkmcnt(0)
    s_mov_b32 s48, s46
    s_and_b32 s49, s47, 0xffff
    s_mov_b32 s50, 0x04000000
    s_mov_b32 s51, 0x00020000
    s_mov_b32 s52, s16
    s_and_b32 s53, s17, 0xffff
    s_mov_b32 s54, 0x00200000
    s_mov_b32 s55, 0x00020000
    s_mov_b32 s56, s40
    s_and_b32 s57, s41, 0xffff
    s_mov_b32 s58, 0x00300000
    s_mov_b32 s59, 0x00020000
    s_mov_b32 s60, s36
    s_and_b32 s61, s37, 0xffff
    s_mov_b32 s62, 0x00158000
    s_mov_b32 s63, 0x00020000
    s_mov_b32 s64, s42
    s_and_b32 s65, s43, 0xffff
    s_mov_b32 s66, 0x00200000
    s_mov_b32 s67, 0x00020000
    s_mov_b32 s68, s44
    s_and_b32 s69, s45, 0xffff
    s_mov_b32 s70, 0x00000100
    s_mov_b32 s71, 0x00020000
    s_mov_b32 s40, s32
    s_and_b32 s41, s33, 0xffff
    s_mov_b32 s42, 0x00158000
    s_mov_b32 s43, 0x00020000
    s_mov_b32 s44, s34
    s_and_b32 s45, s35, 0xffff
    s_mov_b32 s46, 0x00158000
    s_mov_b32 s47, 0x00020000
    s_or_b32 s4, s2, s72
    s_cmp_lg_u32 s4, 0
    s_cbranch_scc1 Lskip_2
    s_or_b32 s100, s100, 1
    v_mov_b32 v8, 0
    v_mov_b32 v9, s100
    s_mov_b64 s[10:11], exec
    s_mov_b64 exec, 1
    buffer_store_dword v9, v8, s[68:71], 0 offen sc1
    s_mov_b64 exec, s[10:11]
Lskip_2:
    s_lshl_b32 s4, s73, 5
    s_add_u32 s4, s4, s74
    s_lshl_b32 s4, s4, 2
    s_add_u32 s4, s4, s72
    s_lshl_b32 s4, s4, 11
    buffer_load_dwordx4 v[36:39], v3, s[52:55], s4 offen
    buffer_load_dwordx4 v[40:43], v3, s[52:55], s4 offen offset:1024
    s_lshl_b32 s5, s72, 11
    s_add_u32 m0, s5, 95744
    s_add_u32 s6, s84, 0xfffffc00
    buffer_load_dwordx4 v12, s[52:55], 0 offen lds
    buffer_load_dwordx4 v13, s[52:55], s6 offen offset:1024 lds
    global_load_ushort v34, v2, s[18:19]
    global_load_ushort v44, v2, s[22:23]
    global_load_ushort v45, v2, s[24:25]
    global_load_ushort v35, v2, s[20:21]
    s_lshl_b32 s5, s75, 1
    s_load_dword s78, s[26:27], s5
    s_load_dword s79, s[28:29], s5
    global_load_dwordx2 v[32:33], v15, s[38:39]
    buffer_load_dwordx4 v[16:19], v14, s[56:59], 0 offen
    buffer_load_dwordx4 v[20:23], v14, s[56:59], s85 offen
    buffer_load_dwordx4 v[24:27], v14, s[56:59], s86 offen
    buffer_load_dwordx4 v[28:31], v14, s[56:59], s87 offen
    s_mul_i32 s4, s76, 2624
    s_add_u32 s4, s4, 16
    s_sub_u32 s5, s4, 68096
    s_add_u32 s6, s4, 512
    v_and_b32 v8, 127, v0
    v_lshlrev_b32 v8, 4, v8
    v_sub_u32 v8, 2047, v8
    v_cvt_f32_i32 v12, v8
    v_lshl_add_u32 v8, v8, 2, s4
    v_add_f32 v13, -1.0, v12
    v_cvt_pk_bf16_f32 v9, |v12|, |v13|
    v_pk_add_f32 v[12:13], v[12:13], -2.0 op_sel_hi:[1,0]
    v_mad_u32_u16 v10, v9, 4, s5 op_sel:[0,0,0,0]
    v_subrev_u32 v46, 0, v8
    v_mad_u32_u16 v11, v9, 4, s5 op_sel:[1,0,0,0]
    v_subrev_u32 v47, 4, v8
    v_med3_i32 v46, v10, v46, s6
    v_med3_i32 v47, v11, v47, s6
    v_cvt_pk_bf16_f32 v9, |v12|, |v13|
    v_pk_add_f32 v[12:13], v[12:13], -2.0 op_sel_hi:[1,0]
    v_mad_u32_u16 v10, v9, 4, s5 op_sel:[0,0,0,0]
    v_subrev_u32 v48, 8, v8
    v_mad_u32_u16 v11, v9, 4, s5 op_sel:[1,0,0,0]
    v_subrev_u32 v49, 12, v8
    v_med3_i32 v48, v10, v48, s6
    v_med3_i32 v49, v11, v49, s6
    v_cvt_pk_bf16_f32 v9, |v12|, |v13|
    v_pk_add_f32 v[12:13], v[12:13], -2.0 op_sel_hi:[1,0]
    v_mad_u32_u16 v10, v9, 4, s5 op_sel:[0,0,0,0]
    v_subrev_u32 v50, 16, v8
    v_mad_u32_u16 v11, v9, 4, s5 op_sel:[1,0,0,0]
    v_subrev_u32 v51, 20, v8
    v_med3_i32 v50, v10, v50, s6
    v_med3_i32 v51, v11, v51, s6
    v_cvt_pk_bf16_f32 v9, |v12|, |v13|
    v_pk_add_f32 v[12:13], v[12:13], -2.0 op_sel_hi:[1,0]
    v_mad_u32_u16 v10, v9, 4, s5 op_sel:[0,0,0,0]
    v_subrev_u32 v52, 24, v8
    v_mad_u32_u16 v11, v9, 4, s5 op_sel:[1,0,0,0]
    v_subrev_u32 v53, 28, v8
    v_med3_i32 v52, v10, v52, s6
    v_med3_i32 v53, v11, v53, s6
    v_cvt_pk_bf16_f32 v9, |v12|, |v13|
    v_pk_add_f32 v[12:13], v[12:13], -2.0 op_sel_hi:[1,0]
    v_mad_u32_u16 v10, v9, 4, s5 op_sel:[0,0,0,0]
    v_subrev_u32 v54, 32, v8
    v_mad_u32_u16 v11, v9, 4, s5 op_sel:[1,0,0,0]
    v_subrev_u32 v55, 36, v8
    v_med3_i32 v54, v10, v54, s6
    v_med3_i32 v55, v11, v55, s6
    v_cvt_pk_bf16_f32 v9, |v12|, |v13|
    v_pk_add_f32 v[12:13], v[12:13], -2.0 op_sel_hi:[1,0]
    v_mad_u32_u16 v10, v9, 4, s5 op_sel:[0,0,0,0]
    v_subrev_u32 v56, 40, v8
    v_mad_u32_u16 v11, v9, 4, s5 op_sel:[1,0,0,0]
    v_subrev_u32 v57, 44, v8
    v_med3_i32 v56, v10, v56, s6
    v_med3_i32 v57, v11, v57, s6
    v_cvt_pk_bf16_f32 v9, |v12|, |v13|
    v_pk_add_f32 v[12:13], v[12:13], -2.0 op_sel_hi:[1,0]
    v_mad_u32_u16 v10, v9, 4, s5 op_sel:[0,0,0,0]
    v_subrev_u32 v58, 48, v8
    v_mad_u32_u16 v11, v9, 4, s5 op_sel:[1,0,0,0]
    v_subrev_u32 v59, 52, v8
    v_med3_i32 v58, v10, v58, s6
    v_med3_i32 v59, v11, v59, s6
    v_cvt_pk_bf16_f32 v9, |v12|, |v13|
    v_pk_add_f32 v[12:13], v[12:13], -2.0 op_sel_hi:[1,0]
    v_mad_u32_u16 v10, v9, 4, s5 op_sel:[0,0,0,0]
    v_subrev_u32 v60, 56, v8
    v_mad_u32_u16 v11, v9, 4, s5 op_sel:[1,0,0,0]
    v_subrev_u32 v61, 60, v8
    v_med3_i32 v60, v10, v60, s6
    v_med3_i32 v61, v11, v61, s6
    v_cvt_pk_bf16_f32 v9, |v12|, |v13|
    v_pk_add_f32 v[12:13], v[12:13], -2.0 op_sel_hi:[1,0]
    v_mad_u32_u16 v10, v9, 4, s5 op_sel:[0,0,0,0]
    v_subrev_u32 v62, 64, v8
    v_mad_u32_u16 v11, v9, 4, s5 op_sel:[1,0,0,0]
    v_subrev_u32 v63, 68, v8
    v_med3_i32 v62, v10, v62, s6
    v_med3_i32 v63, v11, v63, s6
    v_cvt_pk_bf16_f32 v9, |v12|, |v13|
    v_mad_u32_u16 v10, v9, 4, s5 op_sel:[0,0,0,0]
    v_subrev_u32 v64, 72, v8
    v_med3_i32 v64, v10, v64, s6
    v_mov_b32 v12, 0
    v_mov_b32 v13, 0
    v_mov_b32 v14, 0
    v_mov_b32 v15, 0
    v_lshlrev_b32 v8, 4, v0
    ds_write_b128 v8, v[12:15] offset:0
    ds_write_b128 v8, v[12:15] offset:4096
    v_and_b32 v8, 31, v1
    v_lshlrev_b32 v8, 4, v8
    s_mul_i32 s4, s76, 4608
    s_add_u32 s4, s4, 41472
    v_add_u32 v8, s4, v8
    ds_write_b128 v8, v[12:15]
    v_and_b32 v8, 3, v1
    v_mul_u32_u24 v8, 4160, v8
    s_mul_i32 s4, s76, 16640
    s_add_u32 s4, s4, 12288
    v_add_u32 v8, s4, v8
    ds_write_b128 v8, v[12:15]
    ds_write_b128 v8, v[12:15] offset:16
    s_lshr_b32 s80, s2, 2
    s_min_u32 s80, s80, 42
    s_and_b32 s81, s2, 3
    s_lshl_b32 s4, s81, 7
    s_lshl_b32 s5, s72, 5
    s_add_u32 s4, s4, s5
    v_lshrrev_b32 v8, 3, v1
    v_add_u32 v8, s4, v8
    v_mul_u32_u24 v8, 2752, v8
    v_and_b32 v9, 3, v1
    v_lshl_add_u32 v8, v9, 4, v8
    s_lshl_b32 s4, s80, 6
    v_add_u32 v8, s4, v8
    v_and_b32 v9, 4, v1
    v_cmp_eq_u32 vcc, 4, v9
    v_mov_b32 v10, s32
    v_mov_b32 v11, s34
    v_cndmask_b32 v254, v10, v11, vcc
    v_mov_b32 v10, s33
    v_mov_b32 v11, s35
    v_cndmask_b32 v255, v10, v11, vcc
    v_add_co_u32 v254, vcc, v254, v8
    s_nop 1
    v_addc_co_u32 v255, vcc, 0, v255, vcc
    s_lshl_b32 s92, s72, 12
    s_add_u32 s92, s92, 87552
    s_lshl_b32 s4, s2, 2
    s_add_u32 s4, s4, 0
    v_lshl_add_u32 v253, v1, 10, s4
    s_and_b32 s4, s2, 31
    s_lshl_b32 s4, s4, 10
    s_add_u32 s4, s4, 0
    v_lshl_add_u32 v252, v1, 4, s4
    s_lshl_b32 s4, s72, 11
    s_add_u32 s4, s4, 67072
    v_lshl_add_u32 v249, v1, 4, s4
    s_xor_b32 s4, s72, 1
    s_lshl_b32 s4, s4, 11
    s_add_u32 s4, s4, 67072
    v_lshl_add_u32 v248, v1, 4, s4
    s_mul_i32 s4, s76, 2624
    s_add_u32 s4, s4, 16
    v_and_b32 v10, 15, v1
    v_lshrrev_b32 v11, 4, v1
    v_lshlrev_b32 v251, 6, v10
    v_lshl_add_u32 v251, v11, 4, v251
    v_lshrrev_b32 v250, 1, v251
    v_add_u32 v250, 1024, v250
    v_lshlrev_b32 v11, 4, v10
    v_add_u32 v11, 1536, v11
    v_lshlrev_b32 v10, 3, v10
    v_add_u32 v10, 2048, v10
    s_cmp_eq_u32 s77, 0
    s_cselect_b64 vcc, -1, 0
    v_cndmask_b32 v251, v11, v251, vcc
    v_cndmask_b32 v250, v10, v250, vcc
    v_add_u32 v251, s4, v251
    v_add_u32 v250, s4, v250
    v_bfe_u32 v10, v1, 2, 2
    v_cmp_eq_u32 vcc, 3, v10
    s_nop 1
    v_addc_co_u32 v10, vcc, 0, v10, vcc
    v_lshlrev_b32 v10, 14, v10
    v_and_b32 v11, 3, v1
    v_lshl_add_u32 v10, v11, 9, v10
    s_lshl_b32 s6, s73, 11
    s_lshl_b32 s7, s74, 4
    s_add_u32 s6, s6, s7
    s_add_u32 s6, s6, 524288
    v_add_u32 v247, s6, v10
    s_lshl_b32 s97, s75, 12
    s_add_u32 s97, s97, 5242880
    s_add_u32 s98, s97, 4096
    v_lshlrev_b32 v246, 4, v0
    s_mov_b32 s84, 262144
    s_mov_b32 s85, 266240
    s_mov_b32 s86, 270336
    s_mov_b32 s87, 274432
    v_lshrrev_b32 v9, 5, v1
    v_sub_u32 v9, 4, v9
    v_lshlrev_b32 v9, 14, v9
    v_lshl_add_u32 v9, v11, 9, v9
    v_bfe_u32 v10, v1, 2, 3
    v_lshl_add_u32 v9, v10, 5, v9
    s_lshl_b32 s4, s81, 12
    s_lshl_b32 s5, s76, 11
    s_add_u32 s4, s4, s5
    s_lshl_b32 s5, s77, 8
    s_add_u32 s4, s4, s5
    s_add_u32 s4, s4, 524288
    v_add_u32 v245, s4, v9
    s_and_b32 s4, s74, 7
    s_mul_i32 s4, s4, 176128
    s_mul_i32 s5, s72, 43008
    s_add_u32 s4, s4, s5
    s_add_u32 s4, s4, 8388608
    s_lshl_b32 s5, s76, 10
    s_add_u32 s4, s4, s5
    v_lshl_add_u32 v244, v1, 4, s4
    v_xor_b32 v243, 1024, v244
    s_min_u32 s4, s72, 1
    s_add_u32 s4, s4, 84
    s_mul_i32 s5, s72, 21
    s_sub_u32 s4, s4, s5
    s_lshl_b32 s34, s4, 11
    v_mov_b32 v236, -1
    v_mov_b32 v237, -1
    v_mov_b32 v238, -1
    v_mov_b32 v239, -1
    v_lshlrev_b32 v242, 4, v1
    s_lshr_b32 s4, s73, 1
    s_lshl_b32 s4, s4, 2
    s_lshr_b32 s5, s74, 3
    s_add_u32 s4, s4, s5
    s_lshl_b32 s4, s4, 1
    s_add_u32 s4, s4, s76
    s_mul_i32 s4, s4, 176128
    s_add_u32 s4, s4, 10485760
    s_and_b32 s6, s73, 1
    s_lshl_b32 s5, s6, 3
    s_and_b32 s7, s74, 7
    s_add_u32 s5, s5, s7
    s_bfe_u32 s8, s74, 0x10003
    s_and_b32 s6, s6, s8
    s_sub_u32 s5, s5, s6
    s_sub_u32 s8, s8, s6
    s_cmp_eq_u32 s7, 7
    s_cselect_b32 s8, s8, 0
    s_cmp_lg_u32 s8, 0
    s_cselect_b32 s5, 15, s5
    s_lshl_b32 s5, s5, 1
    s_add_u32 s5, s5, s77
    s_mul_i32 s5, s5, 3
    s_add_u32 s6, s5, 0
    s_min_u32 s6, s6, 85
    s_lshl_b32 s6, s6, 10
    s_add_u32 s16, s6, s4
    s_add_u32 s17, s16, 88064
    s_add_u32 s6, s5, 1
    s_min_u32 s6, s6, 85
    s_lshl_b32 s6, s6, 10
    s_add_u32 s30, s6, s4
    s_add_u32 s31, s30, 88064
    s_add_u32 s6, s5, 2
    s_min_u32 s6, s6, 85
    s_lshl_b32 s6, s6, 10
    s_add_u32 s36, s6, s4
    s_add_u32 s37, s36, 88064
    v_and_b32 v241, 127, v0
    v_lshlrev_b32 v241, 5, v241
    s_mul_i32 s4, s76, 16640
    s_add_u32 s4, s4, 8192
    v_add_u32 v241, s4, v241
    v_lshlrev_b32 v234, 3, v0
    v_add_u32 v234, 41952, v234
    v_lshlrev_b32 v235, 4, v0
    v_add_u32 v235, 50688, v235
    v_bfe_u32 v8, v1, 4, 1
    v_lshlrev_b32 v8, 6, v8
    v_lshrrev_b32 v9, 5, v1
    v_lshl_add_u32 v8, v9, 5, v8
    v_bfe_u32 v9, v1, 2, 2
    v_lshl_add_u32 v8, v9, 3, v8
    s_lshl_b32 s4, s72, 7
    s_add_u32 s4, s4, 107776
    v_add_u32 v240, s4, v8
    v_bfe_u32 v8, v1, 2, 2
    v_lshrrev_b32 v9, 5, v1
    v_lshl_add_u32 v8, v9, 2, v8
    v_lshlrev_b32 v8, 7, v8
    v_bfe_u32 v10, v1, 4, 1
    v_lshl_add_u32 v8, v10, 6, v8
    v_and_b32 v10, 3, v1
    v_lshl_add_u32 v8, v10, 3, v8
    s_lshl_b32 s4, s72, 12
    s_add_u32 s4, s4, 87552
    v_add_u32 v233, s4, v8
    v_and_b32 v8, 1, v1
    v_lshlrev_b32 v8, 5, v8
    v_lshl_add_u32 v8, v9, 3, v8
    s_lshl_b32 s4, s72, 7
    s_add_u32 s4, s4, 107776
    v_add_u32 v232, s4, v8
    v_and_b32 v8, 3, v1
    v_sub_u32 v8, 3, v8
    v_mul_u32_u24 v8, 4160, v8
    v_bfe_u32 v9, v1, 2, 2
    v_lshlrev_b32 v9, 3, v9
    v_sub_u32 v8, v8, v9
    v_lshrrev_b32 v9, 4, v1
    v_lshl_add_u32 v8, v9, 4, v8
    s_mul_i32 s4, s76, 16640
    s_lshl_b32 s5, s77, 8
    s_sub_u32 s4, s4, s5
    s_add_u32 s4, s4, 8216
    v_add_u32 v231, s4, v8
    v_and_b32 v8, 15, v1
    v_lshlrev_b32 v8, 5, v8
    v_lshl_add_u32 v8, v9, 4, v8
    s_mul_i32 s4, s76, 4608
    s_lshl_b32 s5, s77, 8
    s_sub_u32 s4, s4, s5
    s_add_u32 s4, s4, 41728
    v_add_u32 v230, s4, v8
    v_and_b32 v8, 15, v1
    v_lshlrev_b32 v10, 6, v8
    v_lshrrev_b32 v9, 4, v1
    v_lshl_add_u32 v10, v9, 4, v10
    s_lshl_b32 s4, s76, 13
    s_lshl_b32 s5, s77, 12
    s_add_u32 s4, s4, s5
    s_add_u32 s4, s4, 50688
    v_add_u32 v229, s4, v10
    v_lshlrev_b32 v221, 4, v1
    s_lshl_b32 s4, s72, 12
    s_add_u32 s4, s4, 67072
    v_add_u32 v228, s4, v221
    v_xor_b32 v227, 4096, v221
    s_and_b32 s5, s72, 1
    s_lshl_b32 s5, s5, 13
    s_sub_u32 s4, s4, s5
    v_add_u32 v227, s4, v227
    v_lshlrev_b32 v10, 3, v1
    v_add_u32 v224, 105216, v10
    s_lshl_b32 s4, s72, 9
    v_add_u32 v226, s4, v224
    v_lshrrev_b32 v10, 5, v1
    v_lshlrev_b32 v10, 10, v10
    v_and_b32 v11, 31, v1
    v_lshl_add_u32 v223, v11, 1, v10
    s_lshl_b32 s4, s80, 11
    s_lshl_b32 s5, s81, 8
    s_add_u32 s4, s4, s5
    s_add_u32 s35, s4, 393216
    v_lshlrev_b32 v8, 5, v8
    v_bfe_u32 v9, v1, 4, 1
    v_lshl_add_u32 v8, v9, 9, v8
    v_lshrrev_b32 v9, 5, v1
    v_lshl_add_u32 v225, v9, 4, v8
    s_add_u32 s4, s75, s76
    s_lshl_b32 s4, s4, 12
    s_lshl_b32 s5, s77, 11
    s_add_u32 s4, s4, s5
    s_add_u32 s21, s4, 1048576
    s_add_u32 s20, s4, 3145728
    v_lshrrev_b32 v8, 4, v1
    v_bfe_u32 v9, v1, 2, 2
    v_and_b32 v10, 3, v1
    v_lshrrev_b32 v11, 1, v8
    v_lshl_add_u32 v9, v11, 2, v9
    v_lshlrev_b32 v9, 7, v9
    v_and_b32 v8, 1, v8
    v_lshl_add_u32 v9, v8, 5, v9
    v_lshl_add_u32 v9, v10, 3, v9
    s_lshl_b32 s4, s72, 11
    s_add_u32 s4, s4, 0
    v_add_u32 v222, s4, v9
    s_and_b32 s4, s2, 1
    s_lshl_b32 s4, s4, 2
    s_add_u32 s4, s4, s72
    s_mul_i32 s4, s4, 176128
    s_lshr_b32 s5, s2, 1
    s_lshl_b32 s5, s5, 11
    s_add_u32 s4, s4, s5
    s_add_u32 s22, s4, 8388608
    v_mov_b32 v8, 0
    buffer_load_dword v2, v8, s[68:71], 0 offen sc1
    s_cmp_lg_u32 s72, 1
    s_cbranch_scc1 Lskip_3
    s_lshl_b32 s4, s2, 8
    s_add_u32 s4, s4, 65536
    v_lshl_add_u32 v8, v1, 16, s4
    v_mov_b32 v9, 0
    s_mov_b32 s4, 1
    s_mov_b64 s[10:11], exec
    s_mov_b32 exec_lo, s4
    s_mov_b32 exec_hi, 0
    buffer_store_dword v9, v8, s[48:51], 0 offen sc1
    s_mov_b64 exec, s[10:11]
Lskip_3:
    v_mov_b32 v65, 0x3f803f80
    s_waitcnt vmcnt(13)
    v_dot2_f32_bf16 v12, v36, v65, 0
    v_dot2_f32_bf16 v14, v36, v36, 0
    s_waitcnt vmcnt(12)
    v_dot2_f32_bf16 v13, v40, v65, 0
    v_dot2_f32_bf16 v15, v40, v40, 0
    v_dot2c_f32_bf16 v12, v37, v65
    v_dot2c_f32_bf16 v14, v37, v37
    v_dot2c_f32_bf16 v13, v41, v65
    v_dot2c_f32_bf16 v15, v41, v41
    v_dot2c_f32_bf16 v12, v38, v65
    v_dot2c_f32_bf16 v14, v38, v38
    v_dot2c_f32_bf16 v13, v42, v65
    v_dot2c_f32_bf16 v15, v42, v42
    v_dot2c_f32_bf16 v12, v39, v65
    v_dot2c_f32_bf16 v14, v39, v39
    v_dot2c_f32_bf16 v13, v43, v65
    v_dot2c_f32_bf16 v15, v43, v43
    s_nop 1
    v_permlane32_swap_b32 v12, v13
    v_permlane32_swap_b32 v14, v15
    v_add_f32 v12, v12, v13
    v_add_f32 v14, v14, v15
    s_nop 0
    v_add_f32_dpp v12, v12, v12 row_shr:1 row_mask:0xf bank_mask:0xf
    v_add_f32_dpp v14, v14, v14 row_shr:1 row_mask:0xf bank_mask:0xf
    s_nop 0
    v_add_f32_dpp v12, v12, v12 row_shr:2 row_mask:0xf bank_mask:0xf
    v_add_f32_dpp v14, v14, v14 row_shr:2 row_mask:0xf bank_mask:0xf
    s_nop 0
    v_add_f32_dpp v12, v12, v12 row_shr:4 row_mask:0xf bank_mask:0xf
    v_add_f32_dpp v14, v14, v14 row_shr:4 row_mask:0xf bank_mask:0xf
    s_nop 0
    v_add_f32_dpp v12, v12, v12 row_shr:8 row_mask:0xf bank_mask:0xf
    v_add_f32_dpp v14, v14, v14 row_shr:8 row_mask:0xf bank_mask:0xf
    s_nop 0
    v_add_f32_dpp v12, v12, v12 row_bcast:15 row_mask:0xa bank_mask:0xf
    v_add_f32_dpp v14, v14, v14 row_bcast:15 row_mask:0xa bank_mask:0xf
    v_mul_f32 v12, 0x3b000000, v12
    v_mul_f32 v14, 0x3b000000, v14
    v_fma_f32 v14, -v12, v12, v14
    v_max_f32 v14, 0, v14
    v_cvt_pk_bf16_f32 v8, v12, v12
    v_lshlrev_b32 v8, 16, v8
    v_cvt_pk_bf16_f32 v14, v14, v14
    v_lshlrev_b32 v14, 16, v14
    v_add_f32 v14, 0x3727c5ac, v14
    v_cvt_pk_bf16_f32 v14, v14, v14
    v_lshlrev_b32 v14, 16, v14
    v_sqrt_f32 v14, v14
    s_nop 0
    v_cvt_pk_bf16_f32 v14, v14, v14
    v_lshlrev_b32 v14, 16, v14
    v_rcp_f32 v69, v14
    s_nop 0
    v_mul_f32 v71, -v8, v69
    v_mov_b32 v68, v69
    v_mov_b32 v70, v71
    s_lshl_b32 s4, s73, 5
    s_add_u32 s4, s4, s74
    s_lshl_b32 s4, s4, 5
    s_lshl_b32 s5, s76, 4
    s_add_u32 s4, s4, s5
    s_lshl_b32 s5, s77, 13
    s_add_u32 s4, s4, s5
    s_add_u32 s4, s4, 262144
    v_mov_b32 v220, s4
    v_permlane32_swap_b32 v68, v69
    v_permlane32_swap_b32 v70, v71
    s_mov_b64 s[10:11], exec
    s_mov_b32 exec_lo, 0
    s_mov_b32 exec_hi, 0x80000000
    buffer_store_dwordx4 v[68:71], v220, s[48:51], 0 offen sc1
    s_mov_b64 exec, s[10:11]
    v_and_b32 v8, 3, v1
    v_lshrrev_b32 v9, 4, v1
    v_lshlrev_b32 v10, 1, v8
    v_xor_b32 v9, v9, v10
    v_lshlrev_b32 v9, 4, v9
    v_lshl_add_u32 v9, v8, 9, v9
    v_bfe_u32 v10, v1, 2, 2
    v_lshl_add_u32 v9, v10, 2, v9
    s_lshl_b32 s4, s72, 11
    s_add_u32 s4, s4, 95744
    v_add_u32 v218, s4, v9
    v_xor_b32 v219, 64, v218
    s_waitcnt vmcnt(11)
    ds_read_b32 v72, v218 offset:0
    ds_read_b32 v73, v218 offset:128
    ds_read_b32 v74, v218 offset:256
    ds_read_b32 v75, v218 offset:384
    ds_read_b32 v76, v219 offset:0
    ds_read_b32 v77, v219 offset:128
    ds_read_b32 v78, v219 offset:256
    ds_read_b32 v79, v219 offset:384
    v_lshrrev_b32 v11, 2, v1
    v_lshlrev_b32 v11, 13, v11
    v_and_b32 v8, 3, v1
    v_lshl_add_u32 v220, v8, 4, v11
    s_lshl_b32 s4, s91, 18
    s_lshl_b32 s5, s90, 8
    s_add_u32 s4, s4, s5
    s_lshl_b32 s5, s72, 6
    s_add_u32 s4, s4, s5
    s_add_u32 s18, s4, 5242880
    s_add_u32 s19, s18, 131072
    s_waitcnt lgkmcnt(0)
    buffer_store_dwordx4 v[72:75], v220, s[48:51], s18 offen sc1
    buffer_store_dwordx4 v[76:79], v220, s[48:51], s19 offen sc1
    s_waitcnt lgkmcnt(0)
    s_lshl_b32 s4, s76, 4
    s_lshr_b32 s4, s78, s4
    s_lshl_b32 s4, s4, 16
    v_mov_b32 v3, s4
    v_mul_f32 v3, 0x3fb8aa3b, v3
    s_waitcnt vmcnt(12)
    v_lshlrev_b32 v34, 16, v34
    v_exp_f32 v3, v3
    v_mul_f32 v34, 0x3fb8aa3b, v34
    s_waitcnt vmcnt(11)
    v_lshlrev_b32 v44, 16, v44
    v_exp_f32 v34, v34
    s_waitcnt vmcnt(10)
    v_lshlrev_b32 v45, 16, v45
    v_max_f32 v8, |v44|, |v45|
    v_cvt_pk_bf16_f32 v3, v3, v3
    v_lshlrev_b32 v3, 16, v3
    s_waitcnt vmcnt(9)
    v_lshlrev_b32 v35, 16, v35
    v_cvt_pk_bf16_f32 v34, v34, v34
    v_lshlrev_b32 v34, 16, v34
    v_max_f32_dpp v8, v8, v8 row_shr:1 row_mask:0xf bank_mask:0xf
    s_nop 1
    v_max_f32_dpp v8, v8, v8 row_shr:2 row_mask:0xf bank_mask:0xf
    s_nop 1
    v_max_f32_dpp v8, v8, v8 row_shr:4 row_mask:0xf bank_mask:0xf
    s_nop 1
    v_max_f32_dpp v8, v8, v8 row_shr:8 row_mask:0xf bank_mask:0xf
    s_nop 1
    v_max_f32_dpp v8, v8, v8 row_bcast:15 row_mask:0xa bank_mask:0xf
    s_nop 1
    v_max_f32_dpp v8, v8, v8 row_bcast:31 row_mask:0xc bank_mask:0xf
    v_mul_f32 v12, v34, v3
    v_mul_f32 v13, v35, v3
    v_readlane_b32 s4, v8, 63
    v_mul_f32 v12, 0xbfb8aa3b, v12
    v_mul_f32 v13, 0x3e22f983, v13
    s_and_b32 s83, s4, 0x7f800000
    s_sub_u32 s4, 0x7f000000, s83
    v_mul_f32 v14, s4, v44
    v_mul_f32 v15, s4, v45
    s_mul_i32 s4, s72, 16416
    s_add_u32 s4, s4, 92128
    s_cmp_eq_u32 s72, 0
    s_cselect_b32 s4, 50688, s4
    v_lshl_add_u32 v220, v1, 2, s4
    v_and_b32 v8, 15, v1
    v_mul_u32_u24 v219, 288, v8
    v_min_u32 v218, 8, v8
    v_mul_u32_u24 v218, 288, v218
    v_lshrrev_b32 v8, 4, v1
    v_lshl_add_u32 v8, v8, 4, s4
    v_add_u32 v219, v8, v219
    v_add_u32 v218, v8, v218
    s_mov_b32 s5, 0x41800000
    s_mov_b32 s6, 0x44000000
    v_mul_f32 v180, s5, v12
    v_mul_f32 v181, s5, v13
    v_mul_f32 v182, s6, v12
    v_mul_f32 v183, s6, v13
    v_exp_f32 v12, v12
    v_fract_f32 v13, v13
    v_exp_f32 v180, v180
    v_fract_f32 v181, v181
    v_exp_f32 v182, v182
    v_fract_f32 v183, v183
    v_cos_f32 v34, v13
    v_sin_f32 v35, v13
    v_cos_f32 v36, v181
    v_sin_f32 v37, v181
    v_cos_f32 v38, v183
    v_sin_f32 v39, v183
    v_pk_mul_f32 v[34:35], v[34:35], v[12:13] op_sel_hi:[1,0]
    v_pk_mul_f32 v[36:37], v[36:37], v[180:181] op_sel_hi:[1,0]
    v_pk_mul_f32 v[38:39], v[38:39], v[182:183] op_sel_hi:[1,0]
    v_mov_b32 v190, 0x3c00
    ds_write_b32 v220, v190 offset:9216
    v_cvt_pk_f16_f32 v186, v14, -v15
    v_cvt_pk_f16_f32 v187, v34, v35
    v_cvt_pk_f16_f32 v188, v38, v39
    ds_write_b32 v220, v186 offset:0
    ds_write_b32 v220, v187 offset:9504
    ds_write_b32 v220, v188 offset:13824
    v_pk_mul_f32 v[178:179], v[34:35], v[34:35] op_sel:[1,1] op_sel_hi:[1,0]
    v_pk_mul_f32 v[180:181], v[36:37], v[36:37] op_sel:[1,1] op_sel_hi:[1,0]
    v_pk_mul_f32 v[182:183], v[38:39], v[38:39] op_sel:[1,1] op_sel_hi:[1,0]
    v_pk_mul_f32 v[184:185], v[14:15], v[36:37] op_sel:[1,1] op_sel_hi:[1,0]
    v_pk_fma_f32 v[40:41], v[34:35], v[34:35], v[178:179] op_sel_hi:[0,1,1] neg_lo:[0,0,1]
    v_pk_fma_f32 v[154:155], v[36:37], v[36:37], v[180:181] op_sel_hi:[0,1,1] neg_lo:[0,0,1]
    v_pk_fma_f32 v[158:159], v[38:39], v[38:39], v[182:183] op_sel_hi:[0,1,1] neg_lo:[0,0,1]
    v_pk_fma_f32 v[166:167], v[14:15], v[36:37], v[184:185] op_sel_hi:[0,1,1] neg_lo:[0,0,1]
    v_cvt_pk_f16_f32 v190, v40, v41
    v_cvt_pk_f16_f32 v191, v158, v159
    v_cvt_pk_f16_f32 v192, v166, -v167
    ds_write_b32 v220, v190 offset:9792
    ds_write_b32 v220, v191 offset:14976
    ds_write_b32 v220, v192 offset:288
    v_pk_mul_f32 v[178:179], v[40:41], v[34:35] op_sel:[1,1] op_sel_hi:[1,0]
    v_pk_mul_f32 v[180:181], v[40:41], v[40:41] op_sel:[1,1] op_sel_hi:[1,0]
    v_pk_mul_f32 v[182:183], v[154:155], v[154:155] op_sel:[1,1] op_sel_hi:[1,0]
    v_pk_mul_f32 v[184:185], v[14:15], v[154:155] op_sel:[1,1] op_sel_hi:[1,0]
    v_pk_fma_f32 v[42:43], v[40:41], v[34:35], v[178:179] op_sel_hi:[0,1,1] neg_lo:[0,0,1]
    v_pk_fma_f32 v[44:45], v[40:41], v[40:41], v[180:181] op_sel_hi:[0,1,1] neg_lo:[0,0,1]
    v_pk_fma_f32 v[156:157], v[154:155], v[154:155], v[182:183] op_sel_hi:[0,1,1] neg_lo:[0,0,1]
    v_pk_fma_f32 v[168:169], v[14:15], v[154:155], v[184:185] op_sel_hi:[0,1,1] neg_lo:[0,0,1]
    v_cvt_pk_f16_f32 v186, v42, v43
    v_cvt_pk_f16_f32 v187, v44, v45
    v_cvt_pk_f16_f32 v188, v168, -v169
    ds_write_b32 v220, v186 offset:10080
    ds_write_b32 v220, v187 offset:10368
    ds_write_b32 v220, v188 offset:576
    v_pk_mul_f32 v[178:179], v[166:167], v[154:155] op_sel:[1,1] op_sel_hi:[1,0]
    v_pk_mul_f32 v[180:181], v[14:15], v[156:157] op_sel:[1,1] op_sel_hi:[1,0]
    v_pk_mul_f32 v[182:183], v[158:159], v[38:39] op_sel:[1,1] op_sel_hi:[1,0]
    v_pk_mul_f32 v[184:185], v[158:159], v[158:159] op_sel:[1,1] op_sel_hi:[1,0]
    v_pk_fma_f32 v[170:171], v[166:167], v[154:155], v[178:179] op_sel_hi:[0,1,1] neg_lo:[0,0,1]
    v_pk_fma_f32 v[164:165], v[14:15], v[156:157], v[180:181] op_sel_hi:[0,1,1] neg_lo:[0,0,1]
    v_pk_fma_f32 v[160:161], v[158:159], v[38:39], v[182:183] op_sel_hi:[0,1,1] neg_lo:[0,0,1]
    v_pk_fma_f32 v[162:163], v[158:159], v[158:159], v[184:185] op_sel_hi:[0,1,1] neg_lo:[0,0,1]
    v_cvt_pk_f16_f32 v190, v170, -v171
    v_cvt_pk_f16_f32 v191, v164, -v165
    v_cvt_pk_f16_f32 v192, v160, v161
    v_cvt_pk_f16_f32 v193, v162, v163
    ds_write_b32 v220, v190 offset:864
    ds_write_b32 v220, v191 offset:1152
    ds_write_b32 v220, v192 offset:15552
    ds_write_b32 v220, v193 offset:16128
    v_pk_mul_f32 v[178:179], v[166:167], v[156:157] op_sel:[1,1] op_sel_hi:[1,0]
    v_pk_mul_f32 v[180:181], v[168:169], v[156:157] op_sel:[1,1] op_sel_hi:[1,0]
    v_pk_mul_f32 v[182:183], v[170:171], v[156:157] op_sel:[1,1] op_sel_hi:[1,0]
    v_pk_mul_f32 v[184:185], v[164:165], v[156:157] op_sel:[1,1] op_sel_hi:[1,0]
    v_pk_fma_f32 v[166:167], v[166:167], v[156:157], v[178:179] op_sel_hi:[0,1,1] neg_lo:[0,0,1]
    v_pk_fma_f32 v[168:169], v[168:169], v[156:157], v[180:181] op_sel_hi:[0,1,1] neg_lo:[0,0,1]
    v_pk_fma_f32 v[170:171], v[170:171], v[156:157], v[182:183] op_sel_hi:[0,1,1] neg_lo:[0,0,1]
    v_pk_fma_f32 v[164:165], v[164:165], v[156:157], v[184:185] op_sel_hi:[0,1,1] neg_lo:[0,0,1]
    v_cvt_pk_f16_f32 v186, v166, -v167
    v_cvt_pk_f16_f32 v187, v168, -v169
    v_cvt_pk_f16_f32 v188, v170, -v171
    v_cvt_pk_f16_f32 v189, v164, -v165
    ds_write_b32 v220, v186 offset:1440
    ds_write_b32 v220, v187 offset:1728
    ds_write_b32 v220, v188 offset:2016
    ds_write_b32 v220, v189 offset:2304
    v_pk_mul_f32 v[178:179], v[166:167], v[156:157] op_sel:[1,1] op_sel_hi:[1,0]
    v_pk_mul_f32 v[180:181], v[168:169], v[156:157] op_sel:[1,1] op_sel_hi:[1,0]
    v_pk_mul_f32 v[182:183], v[170:171], v[156:157] op_sel:[1,1] op_sel_hi:[1,0]
    v_pk_mul_f32 v[184:185], v[164:165], v[156:157] op_sel:[1,1] op_sel_hi:[1,0]
    v_pk_fma_f32 v[166:167], v[166:167], v[156:157], v[178:179] op_sel_hi:[0,1,1] neg_lo:[0,0,1]
    v_pk_fma_f32 v[168:169], v[168:169], v[156:157], v[180:181] op_sel_hi:[0,1,1] neg_lo:[0,0,1]
    v_pk_fma_f32 v[170:171], v[170:171], v[156:157], v[182:183] op_sel_hi:[0,1,1] neg_lo:[0,0,1]
    v_pk_fma_f32 v[164:165], v[164:165], v[156:157], v[184:185] op_sel_hi:[0,1,1] neg_lo:[0,0,1]
    v_cvt_pk_f16_f32 v190, v166, -v167
    v_cvt_pk_f16_f32 v191, v168, -v169
    v_cvt_pk_f16_f32 v192, v170, -v171
    v_cvt_pk_f16_f32 v193, v164, -v165
    ds_write_b32 v220, v190 offset:2592
    ds_write_b32 v220, v191 offset:2880
    ds_write_b32 v220, v192 offset:3168
    ds_write_b32 v220, v193 offset:3456
    v_pk_mul_f32 v[178:179], v[166:167], v[156:157] op_sel:[1,1] op_sel_hi:[1,0]
    v_pk_mul_f32 v[180:181], v[168:169], v[156:157] op_sel:[1,1] op_sel_hi:[1,0]
    v_pk_mul_f32 v[182:183], v[170:171], v[156:157] op_sel:[1,1] op_sel_hi:[1,0]
    v_pk_fma_f32 v[166:167], v[166:167], v[156:157], v[178:179] op_sel_hi:[0,1,1] neg_lo:[0,0,1]
    v_pk_fma_f32 v[168:169], v[168:169], v[156:157], v[180:181] op_sel_hi:[0,1,1] neg_lo:[0,0,1]
    v_pk_fma_f32 v[170:171], v[170:171], v[156:157], v[182:183] op_sel_hi:[0,1,1] neg_lo:[0,0,1]
    v_cvt_pk_f16_f32 v186, v166, -v167
    v_cvt_pk_f16_f32 v187, v168, -v169
    v_cvt_pk_f16_f32 v188, v170, -v171
    ds_write_b32 v220, v186 offset:3744
    ds_write_b32 v220, v187 offset:4032
    ds_write_b32 v220, v188 offset:4320
    s_waitcnt vmcnt(0)
    s_barrier
    s_cmp_lg_u32 s72, 0
    s_cbranch_scc1 Lskip_4
    s_mov_b32 s88, 0
    v_cmp_eq_u32 vcc, 0, v2
    s_cbranch_vccz Lrdyd_6
Lrdy_5:
    v_mov_b32 v8, 0
    buffer_load_dword v2, v8, s[68:71], 0 offen sc1
    s_add_u32 s88, s88, 1
    s_waitcnt vmcnt(0)
    v_cmp_eq_u32 vcc, 0, v2
    s_cmp_gt_u32 s88, 0x40000
    s_cbranch_scc1 Lrdyd_6
    s_cbranch_vccnz Lrdy_5
Lrdyd_6:
    v_readfirstlane_b32 s100, v2
    s_mov_b64 s[10:11], exec
    s_mov_b32 exec_hi, 0
    buffer_store_dword v2, v253, s[48:51], 0 offen sc1
    s_mov_b64 exec, s[10:11]
Lskip_4:
    s_cmp_eq_u32 s72, 0
    s_cbranch_scc1 Lskip_7
    s_add_u32 m0, s92, 0
    s_nop 0
    global_load_lds_dwordx4 v[254:255], off
    v_add_co_u32 v254, vcc, 22016, v254
    s_nop 1
    v_addc_co_u32 v255, vcc, 0, v255, vcc
    s_add_u32 m0, s92, 1024
    s_nop 0
    global_load_lds_dwordx4 v[254:255], off
    v_add_co_u32 v254, vcc, 22016, v254
    s_nop 1
    v_addc_co_u32 v255, vcc, 0, v255, vcc
    s_add_u32 m0, s92, 2048
    s_nop 0
    global_load_lds_dwordx4 v[254:255], off
    v_add_co_u32 v254, vcc, 22016, v254
    s_nop 1
    v_addc_co_u32 v255, vcc, 0, v255, vcc
    s_add_u32 m0, s92, 3072
    s_nop 0
    global_load_lds_dwordx4 v[254:255], off
    s_cmp_lg_u32 s72, 1
    s_cbranch_scc1 Lskip_8
    v_subrev_co_u32 v254, vcc, 154112, v254
    s_nop 1
    v_subbrev_co_u32 v255, vcc, 0, v255, vcc
    s_mov_b32 m0, 87552
    s_nop 0
    global_load_lds_dwordx4 v[254:255], off
    v_add_co_u32 v254, vcc, 22016, v254
    s_nop 1
    v_addc_co_u32 v255, vcc, 0, v255, vcc
    s_mov_b32 m0, 88576
    s_nop 0
    global_load_lds_dwordx4 v[254:255], off
    v_add_co_u32 v254, vcc, 22016, v254
    s_nop 1
    v_addc_co_u32 v255, vcc, 0, v255, vcc
    s_mov_b32 m0, 89600
    s_nop 0
    global_load_lds_dwordx4 v[254:255], off
    v_add_co_u32 v254, vcc, 22016, v254
    s_nop 1
    v_addc_co_u32 v255, vcc, 0, v255, vcc
    s_mov_b32 m0, 90624
    s_nop 0
    global_load_lds_dwordx4 v[254:255], off
Lskip_8:
Lskip_7:
    s_cmp_ge_u32 s99, 192
    s_cbranch_scc1 Lskip_9
    v_lshlrev_b32 v136, 16, v32
    v_and_b32 v137, 0xffff0000, v32
    v_lshlrev_b32 v138, 16, v33
    v_and_b32 v139, 0xffff0000, v33
    v_mul_f32 v140, 0xbfb8aa3b, v136
    v_mul_f32 v141, 0xbfb8aa3b, v137
    v_mul_f32 v142, 0xbfb8aa3b, v138
    v_mul_f32 v143, 0xbfb8aa3b, v139
    v_exp_f32 v140, v140
    v_exp_f32 v141, v141
    v_exp_f32 v142, v142
    v_exp_f32 v143, v143
    v_add_f32 v140, 1.0, v140
    v_add_f32 v141, 1.0, v141
    v_add_f32 v142, 1.0, v142
    v_add_f32 v143, 1.0, v143
    v_rcp_f32 v140, v140
    v_rcp_f32 v141, v141
    v_rcp_f32 v142, v142
    v_rcp_f32 v143, v143
    v_mul_f32 v136, v136, v140
    v_mul_f32 v137, v137, v141
    v_mul_f32 v138, v138, v142
    v_mul_f32 v139, v139, v143
    v_cvt_pk_bf16_f32 v140, v136, v137
    v_cvt_pk_bf16_f32 v141, v138, v139
    s_mov_b32 s4, 0x05040100
    s_mov_b32 s5, 0x07060302
    v_perm_b32 v136, v20, v16, s4
    v_perm_b32 v137, v20, v16, s5
    v_dot2_f32_bf16 v144, v136, v140, 0
    v_dot2_f32_bf16 v145, v137, v140, 0
    v_perm_b32 v136, v21, v17, s4
    v_perm_b32 v137, v21, v17, s5
    v_dot2_f32_bf16 v146, v136, v140, 0
    v_dot2_f32_bf16 v147, v137, v140, 0
    v_perm_b32 v136, v22, v18, s4
    v_perm_b32 v137, v22, v18, s5
    v_dot2_f32_bf16 v148, v136, v140, 0
    v_dot2_f32_bf16 v149, v137, v140, 0
    v_perm_b32 v136, v23, v19, s4
    v_perm_b32 v137, v23, v19, s5
    v_dot2_f32_bf16 v150, v136, v140, 0
    v_dot2_f32_bf16 v151, v137, v140, 0
    v_perm_b32 v136, v28, v24, s4
    v_perm_b32 v137, v28, v24, s5
    v_dot2c_f32_bf16 v144, v136, v141
    v_dot2c_f32_bf16 v145, v137, v141
    v_perm_b32 v136, v29, v25, s4
    v_perm_b32 v137, v29, v25, s5
    v_dot2c_f32_bf16 v146, v136, v141
    v_dot2c_f32_bf16 v147, v137, v141
    v_perm_b32 v136, v30, v26, s4
    v_perm_b32 v137, v30, v26, s5
    v_dot2c_f32_bf16 v148, v136, v141
    v_dot2c_f32_bf16 v149, v137, v141
    v_perm_b32 v136, v31, v27, s4
    v_perm_b32 v137, v31, v27, s5
    v_dot2c_f32_bf16 v150, v136, v141
    v_dot2c_f32_bf16 v151, v137, v141
    v_permlane32_swap_b32 v144, v145
    v_permlane32_swap_b32 v146, v147
    v_permlane32_swap_b32 v148, v149
    v_permlane32_swap_b32 v150, v151
    v_add_f32 v140, v144, v145
    v_add_f32 v141, v146, v147
    v_add_f32 v142, v148, v149
    v_add_f32 v143, v150, v151
    v_permlane16_swap_b32 v140, v141
    s_nop 0
    v_permlane16_swap_b32 v142, v143
    v_add_f32 v136, v140, v141
    v_add_f32 v137, v142, v143
    s_nop 0
    v_add_f32_dpp v136, v136, v136 row_shr:8 row_mask:0xf bank_mask:0xf
    v_add_f32_dpp v137, v137, v137 row_shr:8 row_mask:0xf bank_mask:0xf
    v_and_b32 v8, 7, v1
    v_lshlrev_b32 v8, 5, v8
    v_bfe_u32 v9, v1, 4, 1
    v_lshl_add_u32 v8, v9, 3, v8
    v_lshrrev_b32 v9, 5, v1
    v_lshl_add_u32 v8, v9, 2, v8
    s_lshl_b32 s4, s72, 8
    s_add_u32 s4, s4, 103936
    v_add_u32 v253, s4, v8
    s_mov_b64 s[10:11], exec
    s_mov_b32 exec_lo, 0xff00ff00
    s_mov_b32 exec_hi, 0xff00ff00
    ds_write2_b32 v253, v136, v137 offset0:0 offset1:4
    s_mov_b64 exec, s[10:11]
Lskip_9:
    s_waitcnt lgkmcnt(0)
    s_barrier
    s_cmp_ge_u32 s99, 192
    s_cbranch_scc1 Lskip_10
    s_cmp_lg_u32 s72, 0
    s_cbranch_scc1 Lskip_11
    v_and_b32 v9, 31, v1
    v_lshlrev_b32 v216, 3, v9
    v_add_u32 v216, 103936, v216
    s_lshl_b32 s4, s99, 9
    s_add_u32 s4, s4, 524288
    v_lshl_add_u32 v217, v9, 4, s4
    ds_read_b64 v[136:137], v216 offset:0
    ds_read_b64 v[138:139], v216 offset:256
    ds_read_b64 v[140:141], v216 offset:512
    ds_read_b64 v[142:143], v216 offset:768
    s_waitcnt lgkmcnt(2)
    v_pk_add_f32 v[136:137], v[136:137], v[138:139]
    s_waitcnt lgkmcnt(0)
    v_pk_add_f32 v[140:141], v[140:141], v[142:143]
    v_pk_add_f32 v[136:137], v[136:137], v[140:141]
    v_mov_b32 v138, s100
    v_mov_b32 v139, s100
    s_mov_b64 s[10:11], exec
    s_mov_b32 exec_hi, 0
    buffer_store_dwordx4 v[136:139], v217, s[48:51], 0 offen sc1
    s_mov_b64 exec, s[10:11]
    s_nop 1
Lskip_11:
Lskip_10:
    v_pk_mul_f32 v[178:179], v[34:35], v[44:45] op_sel:[1,1] op_sel_hi:[1,0]
    v_pk_mul_f32 v[180:181], v[40:41], v[44:45] op_sel:[1,1] op_sel_hi:[1,0]
    v_pk_mul_f32 v[182:183], v[42:43], v[44:45] op_sel:[1,1] op_sel_hi:[1,0]
    v_pk_mul_f32 v[184:185], v[44:45], v[44:45] op_sel:[1,1] op_sel_hi:[1,0]
    v_pk_fma_f32 v[172:173], v[34:35], v[44:45], v[178:179] op_sel_hi:[0,1,1] neg_lo:[0,0,1]
    v_pk_fma_f32 v[174:175], v[40:41], v[44:45], v[180:181] op_sel_hi:[0,1,1] neg_lo:[0,0,1]
    v_pk_fma_f32 v[176:177], v[42:43], v[44:45], v[182:183] op_sel_hi:[0,1,1] neg_lo:[0,0,1]
    v_pk_fma_f32 v[66:67], v[44:45], v[44:45], v[184:185] op_sel_hi:[0,1,1] neg_lo:[0,0,1]
    v_cvt_pk_f16_f32 v190, v172, v173
    v_cvt_pk_f16_f32 v191, v174, v175
    v_cvt_pk_f16_f32 v192, v176, v177
    v_cvt_pk_f16_f32 v193, v66, v67
    ds_write_b32 v220, v190 offset:10656
    ds_write_b32 v220, v191 offset:10944
    ds_write_b32 v220, v192 offset:11232
    ds_write_b32 v220, v193 offset:11520
    v_pk_mul_f32 v[178:179], v[172:173], v[44:45] op_sel:[1,1] op_sel_hi:[1,0]
    v_pk_mul_f32 v[180:181], v[174:175], v[44:45] op_sel:[1,1] op_sel_hi:[1,0]
    ds_read_b128 v[88:91], v219 offset:0
    v_pk_mul_f32 v[182:183], v[176:177], v[44:45] op_sel:[1,1] op_sel_hi:[1,0]
    v_pk_mul_f32 v[184:185], v[66:67], v[44:45] op_sel:[1,1] op_sel_hi:[1,0]
    ds_read_b128 v[92:95], v219 offset:64
    v_pk_fma_f32 v[172:173], v[172:173], v[44:45], v[178:179] op_sel_hi:[0,1,1] neg_lo:[0,0,1]
    v_pk_fma_f32 v[174:175], v[174:175], v[44:45], v[180:181] op_sel_hi:[0,1,1] neg_lo:[0,0,1]
    ds_read_b128 v[96:99], v219 offset:128
    v_pk_fma_f32 v[176:177], v[176:177], v[44:45], v[182:183] op_sel_hi:[0,1,1] neg_lo:[0,0,1]
    v_pk_fma_f32 v[152:153], v[66:67], v[44:45], v[184:185] op_sel_hi:[0,1,1] neg_lo:[0,0,1]
    ds_read_b128 v[100:103], v219 offset:192
    v_cvt_pk_f16_f32 v186, v172, v173
    v_cvt_pk_f16_f32 v187, v174, v175
    v_cvt_pk_f16_f32 v188, v176, v177
    v_cvt_pk_f16_f32 v189, v152, v153
    ds_write_b32 v220, v186 offset:11808
    ds_write_b32 v220, v187 offset:12096
    ds_write_b32 v220, v188 offset:12384
    ds_write_b32 v220, v189 offset:12672
    v_pk_mul_f32 v[178:179], v[172:173], v[44:45] op_sel:[1,1] op_sel_hi:[1,0]
    v_pk_mul_f32 v[180:181], v[174:175], v[44:45] op_sel:[1,1] op_sel_hi:[1,0]
    v_pk_mul_f32 v[182:183], v[176:177], v[44:45] op_sel:[1,1] op_sel_hi:[1,0]
    v_pk_mul_f32 v[184:185], v[38:39], v[44:45] op_sel:[1,1] op_sel_hi:[1,0]
    v_pk_fma_f32 v[172:173], v[172:173], v[44:45], v[178:179] op_sel_hi:[0,1,1] neg_lo:[0,0,1]
    v_pk_fma_f32 v[174:175], v[174:175], v[44:45], v[180:181] op_sel_hi:[0,1,1] neg_lo:[0,0,1]
    v_pk_fma_f32 v[176:177], v[176:177], v[44:45], v[182:183] op_sel_hi:[0,1,1] neg_lo:[0,0,1]
    v_pk_fma_f32 v[162:163], v[38:39], v[44:45], v[184:185] op_sel_hi:[0,1,1] neg_lo:[0,0,1]
    v_cvt_pk_f16_f32 v190, v172, v173
    v_cvt_pk_f16_f32 v191, v174, v175
    v_cvt_pk_f16_f32 v192, v176, v177
    v_cvt_pk_f16_f32 v193, v162, v163
    ds_write_b32 v220, v190 offset:12960
    ds_write_b32 v220, v191 offset:13248
    ds_write_b32 v220, v192 offset:13536
    ds_write_b32 v220, v193 offset:14112
    v_pk_mul_f32 v[178:179], v[38:39], v[66:67] op_sel:[1,1] op_sel_hi:[1,0]
    v_pk_mul_f32 v[180:181], v[38:39], v[152:153] op_sel:[1,1] op_sel_hi:[1,0]
    ds_read_b128 v[104:107], v219 offset:9216
    v_pk_mul_f32 v[182:183], v[158:159], v[66:67] op_sel:[1,1] op_sel_hi:[1,0]
    v_pk_mul_f32 v[184:185], v[160:161], v[66:67] op_sel:[1,1] op_sel_hi:[1,0]
    ds_read_b128 v[108:111], v219 offset:9280
    v_pk_fma_f32 v[172:173], v[38:39], v[66:67], v[178:179] op_sel_hi:[0,1,1] neg_lo:[0,0,1]
    v_pk_fma_f32 v[174:175], v[38:39], v[152:153], v[180:181] op_sel_hi:[0,1,1] neg_lo:[0,0,1]
    ds_read_b128 v[112:115], v219 offset:9344
    v_pk_fma_f32 v[176:177], v[158:159], v[66:67], v[182:183] op_sel_hi:[0,1,1] neg_lo:[0,0,1]
    v_pk_fma_f32 v[42:43], v[160:161], v[66:67], v[184:185] op_sel_hi:[0,1,1] neg_lo:[0,0,1]
    ds_read_b128 v[116:119], v219 offset:9408
    v_cvt_pk_f16_f32 v186, v172, v173
    v_cvt_pk_f16_f32 v187, v174, v175
    v_cvt_pk_f16_f32 v188, v176, v177
    v_cvt_pk_f16_f32 v189, v42, v43
    ds_write_b32 v220, v186 offset:14400
    ds_write_b32 v220, v187 offset:14688
    ds_write_b32 v220, v188 offset:15264
    ds_write_b32 v220, v189 offset:15840
    v_pk_mul_f32 v[178:179], v[164:165], v[156:157] op_sel:[1,1] op_sel_hi:[1,0]
    v_pk_mul_f32 v[180:181], v[166:167], v[156:157] op_sel:[1,1] op_sel_hi:[1,0]
    ds_read_b128 v[120:123], v218 offset:13824
    v_pk_mul_f32 v[182:183], v[168:169], v[156:157] op_sel:[1,1] op_sel_hi:[1,0]
    v_pk_mul_f32 v[184:185], v[170:171], v[156:157] op_sel:[1,1] op_sel_hi:[1,0]
    ds_read_b128 v[124:127], v218 offset:13888
    v_pk_fma_f32 v[164:165], v[164:165], v[156:157], v[178:179] op_sel_hi:[0,1,1] neg_lo:[0,0,1]
    v_pk_fma_f32 v[166:167], v[166:167], v[156:157], v[180:181] op_sel_hi:[0,1,1] neg_lo:[0,0,1]
    ds_read_b128 v[128:131], v218 offset:13952
    v_pk_fma_f32 v[168:169], v[168:169], v[156:157], v[182:183] op_sel_hi:[0,1,1] neg_lo:[0,0,1]
    v_pk_fma_f32 v[170:171], v[170:171], v[156:157], v[184:185] op_sel_hi:[0,1,1] neg_lo:[0,0,1]
    ds_read_b128 v[132:135], v218 offset:14016
    v_cvt_pk_f16_f32 v190, v164, -v165
    v_cvt_pk_f16_f32 v191, v166, -v167
    v_cvt_pk_f16_f32 v192, v168, -v169
    s_waitcnt lgkmcnt(11)
    v_mfma_f32_16x16x32_f16 v[72:75], v[104:107], v[88:91], 0
    v_cvt_pk_f16_f32 v193, v170, -v171
    ds_write_b32 v220, v190 offset:4608
    ds_write_b32 v220, v191 offset:4896
    s_waitcnt lgkmcnt(12)
    v_mfma_f32_16x16x32_f16 v[72:75], v[108:111], v[92:95], v[72:75]
    ds_write_b32 v220, v192 offset:5184
    ds_write_b32 v220, v193 offset:5472
    v_pk_mul_f32 v[178:179], v[164:165], v[156:157] op_sel:[1,1] op_sel_hi:[1,0]
    v_pk_mul_f32 v[180:181], v[166:167], v[156:157] op_sel:[1,1] op_sel_hi:[1,0]
    v_pk_mul_f32 v[182:183], v[168:169], v[156:157] op_sel:[1,1] op_sel_hi:[1,0]
    v_pk_mul_f32 v[184:185], v[170:171], v[156:157] op_sel:[1,1] op_sel_hi:[1,0]
    v_pk_fma_f32 v[164:165], v[164:165], v[156:157], v[178:179] op_sel_hi:[0,1,1] neg_lo:[0,0,1]
    v_pk_fma_f32 v[166:167], v[166:167], v[156:157], v[180:181] op_sel_hi:[0,1,1] neg_lo:[0,0,1]
    v_pk_fma_f32 v[168:169], v[168:169], v[156:157], v[182:183] op_sel_hi:[0,1,1] neg_lo:[0,0,1]
    v_pk_fma_f32 v[170:171], v[170:171], v[156:157], v[184:185] op_sel_hi:[0,1,1] neg_lo:[0,0,1]
    v_cvt_pk_f16_f32 v186, v164, -v165
    v_cvt_pk_f16_f32 v187, v166, -v167
    s_waitcnt lgkmcnt(13)
    v_mfma_f32_16x16x32_f16 v[72:75], v[112:115], v[96:99], v[72:75]
    v_cvt_pk_f16_f32 v188, v168, -v169
    v_cvt_pk_f16_f32 v189, v170, -v171
    s_waitcnt lgkmcnt(12)
    v_mfma_f32_16x16x32_f16 v[72:75], v[116:119], v[100:103], v[72:75]
    ds_write_b32 v220, v186 offset:5760
    ds_write_b32 v220, v187 offset:6048
    s_waitcnt lgkmcnt(9)
    v_mfma_f32_16x16x32_f16 v[80:83], v[120:123], v[88:91], 0
    ds_write_b32 v220, v188 offset:6336
    ds_write_b32 v220, v189 offset:6624
    v_pk_mul_f32 v[178:179], v[164:165], v[156:157] op_sel:[1,1] op_sel_hi:[1,0]
    v_pk_mul_f32 v[180:181], v[166:167], v[156:157] op_sel:[1,1] op_sel_hi:[1,0]
    v_pk_mul_f32 v[182:183], v[168:169], v[156:157] op_sel:[1,1] op_sel_hi:[1,0]
    v_pk_mul_f32 v[184:185], v[170:171], v[156:157] op_sel:[1,1] op_sel_hi:[1,0]
    v_pk_fma_f32 v[164:165], v[164:165], v[156:157], v[178:179] op_sel_hi:[0,1,1] neg_lo:[0,0,1]
    v_pk_fma_f32 v[166:167], v[166:167], v[156:157], v[180:181] op_sel_hi:[0,1,1] neg_lo:[0,0,1]
    v_pk_fma_f32 v[168:169], v[168:169], v[156:157], v[182:183] op_sel_hi:[0,1,1] neg_lo:[0,0,1]
    v_pk_fma_f32 v[170:171], v[170:171], v[156:157], v[184:185] op_sel_hi:[0,1,1] neg_lo:[0,0,1]
    v_cvt_pk_f16_f32 v190, v164, -v165
    v_cvt_pk_f16_f32 v191, v166, -v167
    s_waitcnt lgkmcnt(10)
    v_mfma_f32_16x16x32_f16 v[80:83], v[124:127], v[92:95], v[80:83]
    v_cvt_pk_f16_f32 v192, v168, -v169
    v_cvt_pk_f16_f32 v193, v170, -v171
    s_waitcnt lgkmcnt(9)
    v_mfma_f32_16x16x32_f16 v[80:83], v[128:131], v[96:99], v[80:83]
    ds_write_b32 v220, v190 offset:6912
    ds_write_b32 v220, v191 offset:7200
    s_waitcnt lgkmcnt(10)
    v_mfma_f32_16x16x32_f16 v[80:83], v[132:135], v[100:103], v[80:83]
    ds_write_b32 v220, v192 offset:7488
    ds_write_b32 v220, v193 offset:7776
    v_pk_mul_f32 v[178:179], v[164:165], v[156:157] op_sel:[1,1] op_sel_hi:[1,0]
    v_pk_mul_f32 v[180:181], v[166:167], v[156:157] op_sel:[1,1] op_sel_hi:[1,0]
    v_pk_mul_f32 v[182:183], v[168:169], v[156:157] op_sel:[1,1] op_sel_hi:[1,0]
    v_pk_mul_f32 v[184:185], v[170:171], v[156:157] op_sel:[1,1] op_sel_hi:[1,0]
    v_pk_fma_f32 v[164:165], v[164:165], v[156:157], v[178:179] op_sel_hi:[0,1,1] neg_lo:[0,0,1]
    v_pk_fma_f32 v[166:167], v[166:167], v[156:157], v[180:181] op_sel_hi:[0,1,1] neg_lo:[0,0,1]
    v_pk_fma_f32 v[168:169], v[168:169], v[156:157], v[182:183] op_sel_hi:[0,1,1] neg_lo:[0,0,1]
    v_pk_fma_f32 v[170:171], v[170:171], v[156:157], v[184:185] op_sel_hi:[0,1,1] neg_lo:[0,0,1]
    v_cvt_pk_f16_f32 v186, v164, -v165
    v_cvt_pk_f16_f32 v187, v166, -v167
    v_cvt_pk_f16_f32 v188, v168, -v169
    v_cvt_pk_f16_f32 v189, v170, -v171
    ds_write_b32 v220, v186 offset:8064
    ds_write_b32 v220, v187 offset:8352
    ds_write_b32 v220, v188 offset:8640
    ds_write_b32 v220, v189 offset:8928
    ds_read_b128 v[136:139], v219 offset:4608
    ds_read_b128 v[140:143], v219 offset:4672
    ds_read_b128 v[144:147], v219 offset:4736
    ds_read_b128 v[148:151], v219 offset:4800
    s_cmp_lg_u32 s72, 0
    s_cbranch_scc1 Lskip_12
    buffer_load_dwordx4 v[16:19], v252, s[48:51], 0 offen sc1
Lskip_12:
    v_mul_f32 v20, s83, v3
    s_waitcnt lgkmcnt(3)
    v_mfma_f32_16x16x32_f16 v[76:79], v[104:107], v[136:139], 0
    v_mfma_f32_16x16x32_f16 v[84:87], v[120:123], v[136:139], 0
    s_waitcnt lgkmcnt(2)
    v_mfma_f32_16x16x32_f16 v[76:79], v[108:111], v[140:143], v[76:79]
    v_mfma_f32_16x16x32_f16 v[84:87], v[124:127], v[140:143], v[84:87]
    v_add_f32 v20, v20, v20
    s_waitcnt lgkmcnt(1)
    v_mfma_f32_16x16x32_f16 v[76:79], v[112:115], v[144:147], v[76:79]
    v_mfma_f32_16x16x32_f16 v[84:87], v[128:131], v[144:147], v[84:87]
    s_waitcnt lgkmcnt(0)
    v_mfma_f32_16x16x32_f16 v[76:79], v[116:119], v[148:151], v[76:79]
    v_mfma_f32_16x16x32_f16 v[84:87], v[132:135], v[148:151], v[84:87]
    v_pk_mul_f32 v[72:73], v[72:73], v[20:21] op_sel_hi:[1,0]
    v_pk_mul_f32 v[74:75], v[74:75], v[20:21] op_sel_hi:[1,0]
    s_nop 4
    v_pk_mul_f32 v[76:77], v[76:77], v[20:21] op_sel_hi:[1,0]
    v_pk_mul_f32 v[78:79], v[78:79], v[20:21] op_sel_hi:[1,0]
    v_pk_mul_f32 v[80:81], v[80:81], v[20:21] op_sel_hi:[1,0]
    v_pk_mul_f32 v[82:83], v[82:83], v[20:21] op_sel_hi:[1,0]
    v_pk_mul_f32 v[84:85], v[84:85], v[20:21] op_sel_hi:[1,0]
    v_pk_mul_f32 v[86:87], v[86:87], v[20:21] op_sel_hi:[1,0]
    s_cmp_eq_u32 s77, 0
    s_cbranch_scc0 Lskip_13
    ds_write_b128 v249, v[80:83]
    ds_write_b128 v249, v[84:87] offset:1024
Lskip_13:
    s_cmp_eq_u32 s77, 1
    s_cbranch_scc0 Lskip_14
    ds_write_b128 v249, v[72:75]
    ds_write_b128 v249, v[76:79] offset:1024
Lskip_14:
    s_cmp_lg_u32 s72, 0
    s_cbranch_scc1 Lskip_17
    s_mov_b32 s88, 0
    s_waitcnt vmcnt(0)
    v_xor_b32 v16, s100, v16
    v_xor_b32 v17, s100, v17
    v_xor_b32 v18, s100, v18
    v_xor_b32 v19, s100, v19
    v_or3_b32 v16, v16, v17, v18
    v_or_b32 v16, v16, v19
    v_cmp_ne_u32 vcc, 0, v16
    s_cbranch_vccz Lpolld_16
Lpoll_15:
    buffer_load_dwordx4 v[16:19], v252, s[48:51], 0 offen sc1
    s_add_u32 s88, s88, 1
    s_waitcnt vmcnt(0)
    v_xor_b32 v16, s100, v16
    v_xor_b32 v17, s100, v17
    v_xor_b32 v18, s100, v18
    v_xor_b32 v19, s100, v19
    v_or3_b32 v16, v16, v17, v18
    v_or_b32 v16, v16, v19
    v_cmp_ne_u32 vcc, 0, v16
    s_cmp_gt_u32 s88, 0x40000
    s_cbranch_scc1 Lpolld_16
    s_cbranch_vccnz Lpoll_15
Lpolld_16:
    v_mov_b32 v252, 104960
    v_mov_b32 v16, s100
    s_waitcnt vmcnt(0)
    ds_write_b32 v252, v16
Lskip_17:
    s_waitcnt lgkmcnt(0)
    s_barrier
    v_mov_b32 v252, 104960
    ds_read_b32 v2, v252
    buffer_load_dwordx4 v[20:23], v246, s[48:51], s97 offen sc1
    buffer_load_dwordx4 v[28:31], v246, s[48:51], s84 offen sc1
    buffer_load_dwordx4 v[32:35], v246, s[48:51], s86 offen sc1
    buffer_load_dwordx4 v[24:27], v246, s[48:51], s98 offen sc1
    buffer_load_dwordx4 v[36:39], v246, s[48:51], s85 offen sc1
    buffer_load_dwordx4 v[40:43], v246, s[48:51], s87 offen sc1
    buffer_store_dwordx4 v[236:239], v242, s[48:51], s16 offen sc1
    s_waitcnt lgkmcnt(0)
    v_readfirstlane_b32 s100, v2
    ds_read_b128 v[96:99], v248
    ds_read_b128 v[100:103], v248 offset:1024
    s_cmp_eq_u32 s77, 0
    s_cbranch_scc0 Lskip_18
    s_waitcnt lgkmcnt(1)
    v_pk_add_f32 v[96:97], v[96:97], v[72:73]
    s_waitcnt lgkmcnt(1)
    v_pk_add_f32 v[98:99], v[98:99], v[74:75]
    s_waitcnt lgkmcnt(0)
    v_pk_add_f32 v[100:101], v[100:101], v[76:77]
    s_waitcnt lgkmcnt(0)
    v_pk_add_f32 v[102:103], v[102:103], v[78:79]
    s_waitcnt lgkmcnt(1)
    ds_write_b128 v251, v[96:99]
    s_waitcnt lgkmcnt(1)
    ds_write2_b32 v250, v100, v102 offset0:0 offset1:1
Lskip_18:
    s_cmp_eq_u32 s77, 1
    s_cbranch_scc0 Lskip_19
    s_waitcnt lgkmcnt(1)
    v_pk_add_f32 v[96:97], v[96:97], v[80:81]
    s_waitcnt lgkmcnt(1)
    v_pk_add_f32 v[98:99], v[98:99], v[82:83]
    s_waitcnt lgkmcnt(0)
    v_pk_add_f32 v[100:101], v[100:101], v[84:85]
    s_waitcnt lgkmcnt(0)
    v_pk_add_f32 v[102:103], v[102:103], v[86:87]
    s_mov_b64 s[10:11], exec
    s_mov_b64 exec, 0xffff
    s_waitcnt lgkmcnt(1)
    ds_write_b128 v251, v[96:99]
    s_waitcnt lgkmcnt(1)
    ds_write_b128 v251, v[100:103] offset:256
    s_mov_b32 exec_lo, 0xffff0000
    s_waitcnt lgkmcnt(3)
    ds_write_b64 v250, v[96:97]
    s_waitcnt lgkmcnt(4)
    ds_write_b64 v250, v[98:99] offset:256
    s_waitcnt lgkmcnt(4)
    ds_write_b64 v250, v[100:101] offset:128
    s_waitcnt lgkmcnt(5)
    ds_write_b64 v250, v[102:103] offset:384
    s_mov_b32 exec_lo, 0
    s_mov_b32 exec_hi, 1
    s_waitcnt lgkmcnt(7)
    ds_write_b32 v250, v96 offset:512
    s_mov_b64 exec, s[10:11]
Lskip_19:
    buffer_load_dwordx4 v[12:15], v247, s[48:51], 0 offen sc1
    buffer_load_dwordx4 v[88:91], v245, s[48:51], 0 offen sc1
    buffer_load_dwordx4 v[92:95], v245, s[48:51], 0 offen offset:16 sc1
    s_waitcnt lgkmcnt(0)
    s_barrier
    buffer_store_dwordx4 v[236:239], v242, s[48:51], s17 offen sc1
    ds_read_b32 v96, v46
    ds_read_b32 v97, v47
    ds_read_b32 v98, v48
    ds_read_b32 v99, v49
    ds_read_b32 v100, v50
    ds_read_b32 v101, v51
    ds_read_b32 v102, v52
    ds_read_b32 v103, v53
    ds_read_b32 v104, v54
    ds_read_b32 v105, v55
    ds_read_b32 v106, v56
    ds_read_b32 v107, v57
    ds_read_b32 v108, v58
    ds_read_b32 v109, v59
    ds_read_b32 v110, v60
    ds_read_b32 v111, v61
    ds_read_b32 v112, v62
    ds_read_b32 v113, v63
    ds_read_b32 v114, v64
    s_waitcnt lgkmcnt(15)
    v_cvt_pk_bf16_f32 v72, v96, v97
    v_cvt_pk_bf16_f32 v73, v98, v99
    s_waitcnt lgkmcnt(13)
    v_cvt_pk_bf16_f32 v74, v100, v101
    s_waitcnt lgkmcnt(11)
    v_cvt_pk_bf16_f32 v75, v102, v103
    s_waitcnt lgkmcnt(9)
    v_cvt_pk_bf16_f32 v76, v104, v105
    s_waitcnt lgkmcnt(7)
    v_cvt_pk_bf16_f32 v77, v106, v107
    s_waitcnt lgkmcnt(5)
    v_cvt_pk_bf16_f32 v78, v108, v109
    s_waitcnt lgkmcnt(3)
    v_cvt_pk_bf16_f32 v79, v110, v111
    ds_write_b128 v241, v[72:75] offset:0
    ds_write_b128 v241, v[76:79] offset:16
    v_cvt_pk_bf16_f32 v80, v97, v98
    v_cvt_pk_bf16_f32 v81, v99, v100
    v_cvt_pk_bf16_f32 v82, v101, v102
    v_cvt_pk_bf16_f32 v83, v103, v104
    v_cvt_pk_bf16_f32 v84, v105, v106
    v_cvt_pk_bf16_f32 v85, v107, v108
    v_cvt_pk_bf16_f32 v86, v109, v110
    s_waitcnt lgkmcnt(4)
    v_cvt_pk_bf16_f32 v87, v111, v112
    ds_write_b128 v241, v[80:83] offset:4160
    ds_write_b128 v241, v[84:87] offset:4176
    v_cvt_pk_bf16_f32 v72, v98, v99
    v_cvt_pk_bf16_f32 v73, v100, v101
    v_cvt_pk_bf16_f32 v74, v102, v103
    v_cvt_pk_bf16_f32 v75, v104, v105
    v_cvt_pk_bf16_f32 v76, v106, v107
    v_cvt_pk_bf16_f32 v77, v108, v109
    v_cvt_pk_bf16_f32 v78, v110, v111
    s_waitcnt lgkmcnt(5)
    v_cvt_pk_bf16_f32 v79, v112, v113
    ds_write_b128 v241, v[72:75] offset:8320
    ds_write_b128 v241, v[76:79] offset:8336
    v_cvt_pk_bf16_f32 v80, v99, v100
    v_cvt_pk_bf16_f32 v81, v101, v102
    v_cvt_pk_bf16_f32 v82, v103, v104
    v_cvt_pk_bf16_f32 v83, v105, v106
    v_cvt_pk_bf16_f32 v84, v107, v108
    v_cvt_pk_bf16_f32 v85, v109, v110
    v_cvt_pk_bf16_f32 v86, v111, v112
    s_waitcnt lgkmcnt(6)
    v_cvt_pk_bf16_f32 v87, v113, v114
    ds_write_b128 v241, v[80:83] offset:12480
    ds_write_b128 v241, v[84:87] offset:12496
    buffer_store_dwordx4 v[236:239], v242, s[48:51], s30 offen sc1
    buffer_store_dwordx4 v[236:239], v242, s[48:51], s31 offen sc1
    s_mov_b32 s88, 0
    s_waitcnt vmcnt(5)
    v_xor_b32 v8, s100, v14
    s_waitcnt vmcnt(4)
    v_xor_b32 v9, s100, v90
    s_waitcnt vmcnt(3)
    v_xor_b32 v10, s100, v94
    v_or3_b32 v8, v8, v9, v10
    v_cmp_ne_u32 vcc, 0, v8
    s_cbranch_vccnz Lmod_again
Lmod_back:
    v_add_f32_dpp v12, v12, v12 quad_perm:[1,0,3,2] row_mask:0xf bank_mask:0xf
    v_add_f32_dpp v13, v13, v13 quad_perm:[1,0,3,2] row_mask:0xf bank_mask:0xf
    s_nop 0
    v_add_f32_dpp v12, v12, v12 quad_perm:[2,3,0,1] row_mask:0xf bank_mask:0xf
    v_add_f32_dpp v13, v13, v13 quad_perm:[2,3,0,1] row_mask:0xf bank_mask:0xf
    v_cvt_pk_bf16_f32 v12, v12, v13
    v_and_b32 v13, 0xffff0000, v12
    v_lshlrev_b32 v12, 16, v12
    s_nop 1
    v_mov_b32_dpp v2, v12 row_newbcast:0 row_mask:0xf bank_mask:0xf
    v_mov_b32_dpp v3, v13 row_newbcast:0 row_mask:0xf bank_mask:0xf
    v_mov_b32_dpp v16, v12 row_newbcast:4 row_mask:0xf bank_mask:0xf
    v_mov_b32_dpp v17, v13 row_newbcast:4 row_mask:0xf bank_mask:0xf
    v_mov_b32_dpp v18, v12 row_newbcast:8 row_mask:0xf bank_mask:0xf
    v_mov_b32_dpp v19, v13 row_newbcast:8 row_mask:0xf bank_mask:0xf
    v_mov_b32_dpp v44, v12 row_newbcast:12 row_mask:0xf bank_mask:0xf
    v_mov_b32_dpp v45, v13 row_newbcast:12 row_mask:0xf bank_mask:0xf
    v_pk_add_f32 v[16:17], v[16:17], 1.0 op_sel_hi:[1,0]
    v_cvt_pk_bf16_f32 v16, v16, v17
    v_and_b32 v17, 0xffff0000, v16
    v_lshlrev_b32 v16, 16, v16
    v_pk_add_f32 v[44:45], v[44:45], 1.0 op_sel_hi:[1,0]
    v_cvt_pk_bf16_f32 v44, v44, v45
    v_and_b32 v45, 0xffff0000, v44
    v_lshlrev_b32 v44, 16, v44
    s_lshl_b32 s4, s79, 16
    s_and_b32 s5, s79, 0xffff0000
    v_mul_f32 v12, s4, v18
    v_mul_f32 v13, s5, v19
    v_lshlrev_b32 v48, 16, v20
    v_and_b32 v56, 0xffff0000, v20
    v_lshlrev_b32 v49, 16, v21
    v_and_b32 v57, 0xffff0000, v21
    v_lshlrev_b32 v50, 16, v22
    v_and_b32 v58, 0xffff0000, v22
    v_lshlrev_b32 v51, 16, v23
    v_and_b32 v59, 0xffff0000, v23
    v_lshlrev_b32 v52, 16, v24
    v_and_b32 v60, 0xffff0000, v24
    v_lshlrev_b32 v53, 16, v25
    v_and_b32 v61, 0xffff0000, v25
    v_lshlrev_b32 v54, 16, v26
    v_and_b32 v62, 0xffff0000, v26
    v_lshlrev_b32 v55, 16, v27
    v_and_b32 v63, 0xffff0000, v27
    v_pk_fma_f32 v[72:73], v[48:49], v[28:29], v[30:31]
    v_pk_fma_f32 v[74:75], v[50:51], v[32:33], v[34:35]
    v_pk_fma_f32 v[76:77], v[52:53], v[36:37], v[38:39]
    v_pk_fma_f32 v[78:79], v[54:55], v[40:41], v[42:43]
    v_pk_fma_f32 v[72:73], v[72:73], v[16:17], v[2:3] op_sel:[0,0,0] op_sel_hi:[1,0,0]
    v_pk_fma_f32 v[74:75], v[74:75], v[16:17], v[2:3] op_sel:[0,0,0] op_sel_hi:[1,0,0]
    v_pk_fma_f32 v[76:77], v[76:77], v[16:17], v[2:3] op_sel:[0,0,0] op_sel_hi:[1,0,0]
    v_pk_fma_f32 v[78:79], v[78:79], v[16:17], v[2:3] op_sel:[0,0,0] op_sel_hi:[1,0,0]
    v_cvt_pk_bf16_f32 v96, v72, v73
    v_cvt_pk_bf16_f32 v97, v74, v75
    v_cvt_pk_bf16_f32 v98, v76, v77
    v_cvt_pk_bf16_f32 v99, v78, v79
    ds_write_b64 v234, v[96:97] offset:0
    ds_write_b64 v234, v[98:99] offset:2048
    v_pk_fma_f32 v[80:81], v[72:73], v[12:13], v[48:49] op_sel:[0,0,0] op_sel_hi:[1,0,1]
    v_pk_fma_f32 v[82:83], v[74:75], v[12:13], v[50:51] op_sel:[0,0,0] op_sel_hi:[1,0,1]
    v_pk_fma_f32 v[84:85], v[76:77], v[12:13], v[52:53] op_sel:[0,0,0] op_sel_hi:[1,0,1]
    v_pk_fma_f32 v[86:87], v[78:79], v[12:13], v[54:55] op_sel:[0,0,0] op_sel_hi:[1,0,1]
    ds_write_b128 v235, v[80:83] offset:0
    ds_write_b128 v235, v[84:87] offset:4096
    s_nop 1
    v_pk_fma_f32 v[72:73], v[56:57], v[28:29], v[30:31]
    v_pk_fma_f32 v[74:75], v[58:59], v[32:33], v[34:35]
    v_pk_fma_f32 v[76:77], v[60:61], v[36:37], v[38:39]
    v_pk_fma_f32 v[78:79], v[62:63], v[40:41], v[42:43]
    v_pk_fma_f32 v[72:73], v[72:73], v[16:17], v[2:3] op_sel:[0,1,1] op_sel_hi:[1,1,1]
    v_pk_fma_f32 v[74:75], v[74:75], v[16:17], v[2:3] op_sel:[0,1,1] op_sel_hi:[1,1,1]
    v_pk_fma_f32 v[76:77], v[76:77], v[16:17], v[2:3] op_sel:[0,1,1] op_sel_hi:[1,1,1]
    v_pk_fma_f32 v[78:79], v[78:79], v[16:17], v[2:3] op_sel:[0,1,1] op_sel_hi:[1,1,1]
    v_cvt_pk_bf16_f32 v100, v72, v73
    v_cvt_pk_bf16_f32 v101, v74, v75
    v_cvt_pk_bf16_f32 v102, v76, v77
    v_cvt_pk_bf16_f32 v103, v78, v79
    ds_write_b64 v234, v[100:101] offset:4608
    ds_write_b64 v234, v[102:103] offset:6656
    v_pk_fma_f32 v[80:81], v[72:73], v[12:13], v[56:57] op_sel:[0,1,0] op_sel_hi:[1,1,1]
    v_pk_fma_f32 v[82:83], v[74:75], v[12:13], v[58:59] op_sel:[0,1,0] op_sel_hi:[1,1,1]
    v_pk_fma_f32 v[84:85], v[76:77], v[12:13], v[60:61] op_sel:[0,1,0] op_sel_hi:[1,1,1]
    v_pk_fma_f32 v[86:87], v[78:79], v[12:13], v[62:63] op_sel:[0,1,0] op_sel_hi:[1,1,1]
    ds_write_b128 v235, v[80:83] offset:8192
    ds_write_b128 v235, v[84:87] offset:12288
    buffer_store_dwordx4 v[236:239], v242, s[48:51], s36 offen sc1
    s_lshr_b32 s4, s73, 1
    s_lshl_b32 s4, s4, 2
    s_lshr_b32 s5, s74, 3
    s_add_u32 s25, s4, s5
    s_and_b32 s4, s73, 1
    s_lshl_b32 s26, s4, 3
    s_and_b32 s5, s74, 7
    s_add_u32 s26, s26, s5
    s_bfe_u32 s6, s74, 0x10003
    s_and_b32 s4, s4, s6
    s_sub_u32 s26, s26, s4
    s_sub_u32 s6, s6, s4
    s_cmp_eq_u32 s5, 7
    s_cselect_b32 s6, s6, 0
    s_cmp_lg_u32 s6, 0
    s_cselect_b32 s26, 15, s26
    s_mul_i32 s4, s26, 192
    s_mul_i32 s5, s72, 44032
    s_add_u32 s23, s4, s5
    s_mul_i32 s24, s72, 6208
    v_add_u32 v8, 0, v1
    v_mul_u32_u24 v9, 5462, v8
    v_lshrrev_b32 v9, 16, v9
    v_mul_u32_u24 v10, 12, v9
    v_sub_u32 v10, v8, v10
    v_mul_u32_u24 v9, 2752, v9
    v_lshl_add_u32 v253, v10, 4, v9
    v_add_u32 v8, 64, v1
    v_mul_u32_u24 v9, 5462, v8
    v_lshrrev_b32 v9, 16, v9
    v_mul_u32_u24 v10, 12, v9
    v_sub_u32 v10, v8, v10
    v_mul_u32_u24 v9, 2752, v9
    v_lshl_add_u32 v252, v10, 4, v9
    v_subrev_u32 v252, 1024, v252
    v_add_u32 v8, 128, v1
    v_mul_u32_u24 v9, 5462, v8
    v_lshrrev_b32 v9, 16, v9
    v_mul_u32_u24 v10, 12, v9
    v_sub_u32 v10, v8, v10
    v_mul_u32_u24 v9, 2752, v9
    v_lshl_add_u32 v251, v10, 4, v9
    v_subrev_u32 v251, 2048, v251
    v_add_f32_dpp v88, v88, v88 quad_perm:[1,0,3,2] row_mask:0xf bank_mask:0xf
    v_add_f32_dpp v89, v89, v89 quad_perm:[1,0,3,2] row_mask:0xf bank_mask:0xf
    v_add_f32_dpp v92, v92, v92 quad_perm:[1,0,3,2] row_mask:0xf bank_mask:0xf
    v_add_f32_dpp v93, v93, v93 quad_perm:[1,0,3,2] row_mask:0xf bank_mask:0xf
    v_add_f32_dpp v88, v88, v88 quad_perm:[2,3,0,1] row_mask:0xf bank_mask:0xf
    v_add_f32_dpp v89, v89, v89 quad_perm:[2,3,0,1] row_mask:0xf bank_mask:0xf
    v_add_f32_dpp v92, v92, v92 quad_perm:[2,3,0,1] row_mask:0xf bank_mask:0xf
    v_add_f32_dpp v93, v93, v93 quad_perm:[2,3,0,1] row_mask:0xf bank_mask:0xf
    v_cmp_gt_u32 vcc, 32, v1
    s_nop 1
    v_cndmask_b32 v2, 0, 1.0, vcc
    v_cvt_pk_bf16_f32 v88, v88, v89
    v_cvt_pk_bf16_f32 v90, v92, v93
    v_and_b32 v89, 0xffff0000, v88
    v_lshlrev_b32 v88, 16, v88
    v_add_f32 v88, v88, v2
    v_add_f32 v89, v89, v2
    v_and_b32 v91, 0xffff0000, v90
    v_lshlrev_b32 v90, 16, v90
    v_add_f32 v90, v90, v2
    v_add_f32 v91, v91, v2
    v_cvt_pk_bf16_f32 v88, v88, v89
    v_cvt_pk_bf16_f32 v89, v90, v91
    ds_write_b64 v240, v[88:89]
    s_cmp_eq_u32 s76, 0
    s_cselect_b64 vcc, -1, 0
    v_cndmask_b32 v12, v19, v18, vcc
    v_cndmask_b32 v14, v45, v44, vcc
    s_waitcnt lgkmcnt(0)
    s_barrier
    s_cmp_ge_u32 s2, 172
    s_cbranch_scc1 Lskip_20
    v_lshrrev_b32 v8, 3, v1
    v_and_b32 v9, 7, v1
    v_lshlrev_b32 v9, 4, v9
    v_lshl_add_u32 v8, v8, 10, v9
    s_lshr_b32 s4, s2, 1
    s_lshl_b32 s4, s4, 14
    s_and_b32 s6, s2, 1
    s_lshl_b32 s6, s6, 9
    s_add_u32 s4, s4, s6
    s_lshl_b32 s6, s72, 7
    s_add_u32 s4, s4, s6
    s_lshl_b32 s5, s72, 11
    s_add_u32 m0, s5, 0
    s_add_u32 s6, s4, 7168
    buffer_load_dwordx4 v8, s[60:63], s4 offen lds
    buffer_load_dwordx4 v8, s[60:63], s6 offen offset:1024 lds
Lskip_20:
    ds_read_b128 a[176:179], v230 offset:192
    ds_read_b64 v[48:49], v231 offset:4032
    ds_read_b64 v[50:51], v231 offset:4040
    ds_read_b128 a[180:183], v230 offset:704
    ds_read_b64 v[52:53], v231 offset:3520
    ds_read_b64 v[54:55], v231 offset:3528
    ds_read_b128 a[184:187], v230 offset:1216
    ds_read_b64 v[56:57], v231 offset:3008
    ds_read_b64 v[58:59], v231 offset:3016
    ds_read_b128 a[188:191], v230 offset:1728
    ds_read_b64 v[60:61], v231 offset:2496
    ds_read_b64 v[62:63], v231 offset:2504
    ds_read_b128 a[192:195], v230 offset:2240
    ds_read_b64 v[64:65], v231 offset:1984
    ds_read_b64 v[66:67], v231 offset:1992
    ds_read_b128 a[196:199], v230 offset:2752
    ds_read_b64 v[72:73], v231 offset:1472
    ds_read_b64 v[74:75], v231 offset:1480
    ds_read_b128 a[200:203], v230 offset:3264
    ds_read_b64 v[76:77], v231 offset:960
    ds_read_b64 v[78:79], v231 offset:968
    ds_read_b128 a[204:207], v230 offset:3776
    ds_read_b64 v[80:81], v231 offset:448
    ds_read_b64 v[82:83], v231 offset:456
    s_waitcnt lgkmcnt(15)
    v_mfma_f32_16x16x32_bf16 v[128:131], v[48:51], a[176:179], 0
    v_mfma_f32_16x16x32_bf16 v[132:135], v[48:51], a[180:183], 0
    ds_read_b128 a[208:211], v230 offset:128
    v_mfma_f32_16x16x32_bf16 v[132:135], v[52:55], a[176:179], v[132:135]
    ds_read_b64 v[84:85], v231 offset:3968
    v_mfma_f32_16x16x32_bf16 v[136:139], v[52:55], a[180:183], 0
    ds_read_b64 v[86:87], v231 offset:3976
    v_mfma_f32_16x16x32_bf16 v[136:139], v[48:51], a[184:187], v[136:139]
    ds_read_b128 a[212:215], v230 offset:640
    v_mfma_f32_16x16x32_bf16 v[136:139], v[56:59], a[176:179], v[136:139]
    s_add_u32 m0, s24, 108544
    v_mfma_f32_16x16x32_bf16 v[140:143], v[52:55], a[184:187], 0
    ds_read_b64 v[160:161], v231 offset:3456
    v_mfma_f32_16x16x32_bf16 v[140:143], v[56:59], a[180:183], v[140:143]
    ds_read_b64 v[162:163], v231 offset:3464
    v_mfma_f32_16x16x32_bf16 v[144:147], v[56:59], a[184:187], 0
    ds_read_b128 a[216:219], v230 offset:1152
    s_waitcnt lgkmcnt(15)
    v_mfma_f32_16x16x32_bf16 v[140:143], v[48:51], a[188:191], v[140:143]
    ds_read_b64 v[164:165], v231 offset:2944
    v_mfma_f32_16x16x32_bf16 v[140:143], v[60:63], a[176:179], v[140:143]
    buffer_load_dwordx4 v253, s[40:43], s23 offen offset:0 lds
    v_mfma_f32_16x16x32_bf16 v[144:147], v[52:55], a[188:191], v[144:147]
    ds_read_b64 v[166:167], v231 offset:2952
    v_mfma_f32_16x16x32_bf16 v[144:147], v[60:63], a[180:183], v[144:147]
    ds_read_b128 a[220:223], v230 offset:1664
    v_mfma_f32_16x16x32_bf16 v[148:151], v[56:59], a[188:191], 0
    ds_read_b64 v[168:169], v231 offset:2432
    v_mfma_f32_16x16x32_bf16 v[148:151], v[60:63], a[184:187], v[148:151]
    ds_read_b64 v[170:171], v231 offset:2440
    v_mfma_f32_16x16x32_bf16 v[152:155], v[60:63], a[188:191], 0
    buffer_load_dwordx4 v252, s[40:43], s23 offen offset:1024 lds
    v_mfma_f32_16x16x32_bf16 v[144:147], v[48:51], a[192:195], v[144:147]
    ds_read_b128 a[224:227], v230 offset:2176
    v_mfma_f32_16x16x32_bf16 v[144:147], v[64:67], a[176:179], v[144:147]
    ds_read_b64 v[172:173], v231 offset:1920
    v_mfma_f32_16x16x32_bf16 v[148:151], v[52:55], a[192:195], v[148:151]
    ds_read_b64 v[174:175], v231 offset:1928
    v_mfma_f32_16x16x32_bf16 v[148:151], v[64:67], a[180:183], v[148:151]
    ds_read_b128 a[228:231], v230 offset:2688
    v_mfma_f32_16x16x32_bf16 v[152:155], v[56:59], a[192:195], v[152:155]
    v_mfma_f32_16x16x32_bf16 v[152:155], v[64:67], a[184:187], v[152:155]
    buffer_load_dwordx4 v251, s[40:43], s23 offen offset:2048 lds
    ds_read_b64 v[176:177], v231 offset:1408
    v_mfma_f32_16x16x32_bf16 v[156:159], v[60:63], a[192:195], 0
    ds_read_b64 v[178:179], v231 offset:1416
    v_mfma_f32_16x16x32_bf16 v[156:159], v[64:67], a[188:191], v[156:159]
    ds_read_b128 a[232:235], v230 offset:3200
    v_mfma_f32_16x16x32_bf16 v[148:151], v[48:51], a[196:199], v[148:151]
    ds_read_b64 v[180:181], v231 offset:896
    s_waitcnt lgkmcnt(15)
    v_mfma_f32_16x16x32_bf16 v[148:151], v[72:75], a[176:179], v[148:151]
    v_mfma_f32_16x16x32_bf16 v[152:155], v[52:55], a[196:199], v[152:155]
    s_add_u32 m0, s24, 111648
    ds_read_b64 v[182:183], v231 offset:904
    v_mfma_f32_16x16x32_bf16 v[152:155], v[72:75], a[180:183], v[152:155]
    ds_read_b128 a[236:239], v230 offset:3712
    v_mfma_f32_16x16x32_bf16 v[156:159], v[56:59], a[196:199], v[156:159]
    ds_read_b64 v[184:185], v231 offset:384
    v_mfma_f32_16x16x32_bf16 v[156:159], v[72:75], a[184:187], v[156:159]
    ds_read_b64 v[186:187], v231 offset:392
    v_mfma_f32_16x16x32_bf16 v[152:155], v[48:51], a[200:203], v[152:155]
    v_mfma_f32_16x16x32_bf16 v[152:155], v[76:79], a[176:179], v[152:155]
    buffer_load_dwordx4 v253, s[44:47], s23 offen offset:0 lds
    v_mfma_f32_16x16x32_bf16 v[156:159], v[52:55], a[200:203], v[156:159]
    v_mfma_f32_16x16x32_bf16 v[156:159], v[76:79], a[180:183], v[156:159]
    v_mfma_f32_16x16x32_bf16 v[156:159], v[48:51], a[204:207], v[156:159]
    v_mfma_f32_16x16x32_bf16 v[156:159], v[80:83], a[176:179], v[156:159]
    v_mfma_f32_16x16x32_bf16 v[128:131], v[84:87], a[208:211], v[128:131]
    buffer_load_dwordx4 v252, s[44:47], s23 offen offset:1024 lds
    v_mfma_f32_16x16x32_bf16 v[132:135], v[84:87], a[212:215], v[132:135]
    ds_read_b128 a[176:179], v230 offset:64
    s_waitcnt lgkmcnt(15)
    v_mfma_f32_16x16x32_bf16 v[132:135], v[160:163], a[208:211], v[132:135]
    ds_read_b64 v[48:49], v231 offset:3904
    v_mfma_f32_16x16x32_bf16 v[136:139], v[160:163], a[212:215], v[136:139]
    ds_read_b64 v[50:51], v231 offset:3912
    v_mfma_f32_16x16x32_bf16 v[136:139], v[84:87], a[216:219], v[136:139]
    ds_read_b128 a[180:183], v230 offset:576
    v_mfma_f32_16x16x32_bf16 v[136:139], v[164:167], a[208:211], v[136:139]
    v_mfma_f32_16x16x32_bf16 v[140:143], v[160:163], a[216:219], v[140:143]
    buffer_load_dwordx4 v251, s[44:47], s23 offen offset:2048 lds
    ds_read_b64 v[52:53], v231 offset:3392
    v_mfma_f32_16x16x32_bf16 v[140:143], v[164:167], a[212:215], v[140:143]
    ds_read_b64 v[54:55], v231 offset:3400
    v_mfma_f32_16x16x32_bf16 v[144:147], v[164:167], a[216:219], v[144:147]
    ds_read_b128 a[184:187], v230 offset:1088
    v_mfma_f32_16x16x32_bf16 v[140:143], v[84:87], a[220:223], v[140:143]
    ds_read_b64 v[56:57], v231 offset:2880
    s_waitcnt lgkmcnt(15)
    v_mfma_f32_16x16x32_bf16 v[140:143], v[168:171], a[208:211], v[140:143]
    v_mfma_f32_16x16x32_bf16 v[144:147], v[160:163], a[220:223], v[144:147]
    s_add_u32 s23, s23, 176128
    ds_read_b64 v[58:59], v231 offset:2888
    v_mfma_f32_16x16x32_bf16 v[144:147], v[168:171], a[212:215], v[144:147]
    ds_read_b128 a[188:191], v230 offset:1600
    v_mfma_f32_16x16x32_bf16 v[148:151], v[164:167], a[220:223], v[148:151]
    ds_read_b64 v[60:61], v231 offset:2368
    v_mfma_f32_16x16x32_bf16 v[148:151], v[168:171], a[216:219], v[148:151]
    ds_read_b64 v[62:63], v231 offset:2376
    v_mfma_f32_16x16x32_bf16 v[152:155], v[168:171], a[220:223], v[152:155]
    v_mfma_f32_16x16x32_bf16 v[144:147], v[84:87], a[224:227], v[144:147]
    s_add_u32 m0, s24, 133376
    ds_read_b128 a[192:195], v230 offset:2112
    v_mfma_f32_16x16x32_bf16 v[144:147], v[172:175], a[208:211], v[144:147]
    ds_read_b64 v[64:65], v231 offset:1856
    v_mfma_f32_16x16x32_bf16 v[148:151], v[160:163], a[224:227], v[148:151]
    ds_read_b64 v[66:67], v231 offset:1864
    v_mfma_f32_16x16x32_bf16 v[148:151], v[172:175], a[212:215], v[148:151]
    ds_read_b128 a[196:199], v230 offset:2624
    v_mfma_f32_16x16x32_bf16 v[152:155], v[164:167], a[224:227], v[152:155]
    v_mfma_f32_16x16x32_bf16 v[152:155], v[172:175], a[216:219], v[152:155]
    buffer_load_dwordx4 v253, s[40:43], s23 offen offset:0 lds
    ds_read_b64 v[72:73], v231 offset:1344
    v_mfma_f32_16x16x32_bf16 v[156:159], v[168:171], a[224:227], v[156:159]
    ds_read_b64 v[74:75], v231 offset:1352
    v_mfma_f32_16x16x32_bf16 v[156:159], v[172:175], a[220:223], v[156:159]
    ds_read_b128 a[200:203], v230 offset:3136
    v_mfma_f32_16x16x32_bf16 v[148:151], v[84:87], a[228:231], v[148:151]
    ds_read_b64 v[76:77], v231 offset:832
    s_waitcnt lgkmcnt(15)
    v_mfma_f32_16x16x32_bf16 v[148:151], v[176:179], a[208:211], v[148:151]
    v_mfma_f32_16x16x32_bf16 v[152:155], v[160:163], a[228:231], v[152:155]
    ds_read_b64 v[78:79], v231 offset:840
    v_mfma_f32_16x16x32_bf16 v[152:155], v[176:179], a[212:215], v[152:155]
    buffer_load_dwordx4 v252, s[40:43], s23 offen offset:1024 lds
    ds_read_b128 a[204:207], v230 offset:3648
    v_mfma_f32_16x16x32_bf16 v[156:159], v[164:167], a[228:231], v[156:159]
    ds_read_b64 v[80:81], v231 offset:320
    v_mfma_f32_16x16x32_bf16 v[156:159], v[176:179], a[216:219], v[156:159]
    ds_read_b64 v[82:83], v231 offset:328
    v_mfma_f32_16x16x32_bf16 v[152:155], v[84:87], a[232:235], v[152:155]
    v_mfma_f32_16x16x32_bf16 v[152:155], v[180:183], a[208:211], v[152:155]
    v_mfma_f32_16x16x32_bf16 v[156:159], v[160:163], a[232:235], v[156:159]
    buffer_load_dwordx4 v251, s[40:43], s23 offen offset:2048 lds
    v_mfma_f32_16x16x32_bf16 v[156:159], v[180:183], a[212:215], v[156:159]
    v_mfma_f32_16x16x32_bf16 v[156:159], v[84:87], a[236:239], v[156:159]
    v_mfma_f32_16x16x32_bf16 v[156:159], v[184:187], a[208:211], v[156:159]
    v_mfma_f32_16x16x32_bf16 v[128:131], v[48:51], a[176:179], v[128:131]
    v_mfma_f32_16x16x32_bf16 v[132:135], v[48:51], a[180:183], v[132:135]
    s_add_u32 m0, s24, 136480
    ds_read_b128 a[208:211], v230 offset:0
    s_waitcnt lgkmcnt(15)
    v_mfma_f32_16x16x32_bf16 v[132:135], v[52:55], a[176:179], v[132:135]
    ds_read_b64 v[84:85], v231 offset:3840
    v_mfma_f32_16x16x32_bf16 v[136:139], v[52:55], a[180:183], v[136:139]
    ds_read_b64 v[86:87], v231 offset:3848
    v_mfma_f32_16x16x32_bf16 v[136:139], v[48:51], a[184:187], v[136:139]
    ds_read_b128 a[212:215], v230 offset:512
    v_mfma_f32_16x16x32_bf16 v[136:139], v[56:59], a[176:179], v[136:139]
    v_mfma_f32_16x16x32_bf16 v[140:143], v[52:55], a[184:187], v[140:143]
    buffer_load_dwordx4 v253, s[44:47], s23 offen offset:0 lds
    ds_read_b64 v[160:161], v231 offset:3328
    v_mfma_f32_16x16x32_bf16 v[140:143], v[56:59], a[180:183], v[140:143]
    ds_read_b64 v[162:163], v231 offset:3336
    v_mfma_f32_16x16x32_bf16 v[144:147], v[56:59], a[184:187], v[144:147]
    ds_read_b128 a[216:219], v230 offset:1024
    v_mfma_f32_16x16x32_bf16 v[140:143], v[48:51], a[188:191], v[140:143]
    ds_read_b64 v[164:165], v231 offset:2816
    s_waitcnt lgkmcnt(15)
    v_mfma_f32_16x16x32_bf16 v[140:143], v[60:63], a[176:179], v[140:143]
    v_mfma_f32_16x16x32_bf16 v[144:147], v[52:55], a[188:191], v[144:147]
    ds_read_b64 v[166:167], v231 offset:2824
    v_mfma_f32_16x16x32_bf16 v[144:147], v[60:63], a[180:183], v[144:147]
    buffer_load_dwordx4 v252, s[44:47], s23 offen offset:1024 lds
    ds_read_b128 a[220:223], v230 offset:1536
    v_mfma_f32_16x16x32_bf16 v[148:151], v[56:59], a[188:191], v[148:151]
    ds_read_b64 v[168:169], v231 offset:2304
    v_mfma_f32_16x16x32_bf16 v[148:151], v[60:63], a[184:187], v[148:151]
    ds_read_b64 v[170:171], v231 offset:2312
    v_mfma_f32_16x16x32_bf16 v[152:155], v[60:63], a[188:191], v[152:155]
    v_mfma_f32_16x16x32_bf16 v[144:147], v[48:51], a[192:195], v[144:147]
    ds_read_b128 a[224:227], v230 offset:2048
    v_mfma_f32_16x16x32_bf16 v[144:147], v[64:67], a[176:179], v[144:147]
    buffer_load_dwordx4 v251, s[44:47], s23 offen offset:2048 lds
    ds_read_b64 v[172:173], v231 offset:1792
    v_mfma_f32_16x16x32_bf16 v[148:151], v[52:55], a[192:195], v[148:151]
    ds_read_b64 v[174:175], v231 offset:1800
    v_mfma_f32_16x16x32_bf16 v[148:151], v[64:67], a[180:183], v[148:151]
    ds_read_b128 a[228:231], v230 offset:2560
    v_mfma_f32_16x16x32_bf16 v[152:155], v[56:59], a[192:195], v[152:155]
    v_mfma_f32_16x16x32_bf16 v[152:155], v[64:67], a[184:187], v[152:155]
    ds_read_b64 v[176:177], v231 offset:1280
    v_mfma_f32_16x16x32_bf16 v[156:159], v[60:63], a[192:195], v[156:159]
    s_add_u32 s23, s23, 176128
    ds_read_b64 v[178:179], v231 offset:1288
    v_mfma_f32_16x16x32_bf16 v[156:159], v[64:67], a[188:191], v[156:159]
    ds_read_b128 a[232:235], v230 offset:3072
    v_mfma_f32_16x16x32_bf16 v[148:151], v[48:51], a[196:199], v[148:151]
    ds_read_b64 v[180:181], v231 offset:768
    s_waitcnt lgkmcnt(15)
    v_mfma_f32_16x16x32_bf16 v[148:151], v[72:75], a[176:179], v[148:151]
    v_mfma_f32_16x16x32_bf16 v[152:155], v[52:55], a[196:199], v[152:155]
    ds_read_b64 v[182:183], v231 offset:776
    v_mfma_f32_16x16x32_bf16 v[152:155], v[72:75], a[180:183], v[152:155]
    buffer_store_dwordx4 v[236:239], v242, s[48:51], s37 offen sc1
    ds_read_b128 a[236:239], v230 offset:3584
    v_mfma_f32_16x16x32_bf16 v[156:159], v[56:59], a[196:199], v[156:159]
    ds_read_b64 v[184:185], v231 offset:256
    v_mfma_f32_16x16x32_bf16 v[156:159], v[72:75], a[184:187], v[156:159]
    ds_read_b64 v[186:187], v231 offset:264
    v_mfma_f32_16x16x32_bf16 v[152:155], v[48:51], a[200:203], v[152:155]
    v_mfma_f32_16x16x32_bf16 v[152:155], v[76:79], a[176:179], v[152:155]
    v_mfma_f32_16x16x32_bf16 v[156:159], v[52:55], a[200:203], v[156:159]
    v_mfma_f32_16x16x32_bf16 v[156:159], v[76:79], a[180:183], v[156:159]
    v_mfma_f32_16x16x32_bf16 v[156:159], v[48:51], a[204:207], v[156:159]
    v_mfma_f32_16x16x32_bf16 v[156:159], v[80:83], a[176:179], v[156:159]
    v_mfma_f32_16x16x32_bf16 v[128:131], v[84:87], a[208:211], v[128:131]
    v_mfma_f32_16x16x32_bf16 v[132:135], v[84:87], a[212:215], v[132:135]
    s_waitcnt lgkmcnt(15)
    v_mfma_f32_16x16x32_bf16 v[132:135], v[160:163], a[208:211], v[132:135]
    v_mfma_f32_16x16x32_bf16 v[136:139], v[160:163], a[212:215], v[136:139]
    v_mfma_f32_16x16x32_bf16 v[136:139], v[84:87], a[216:219], v[136:139]
    ds_read_b64 v[36:37], v232 offset:0
    v_mfma_f32_16x16x32_bf16 v[136:139], v[164:167], a[208:211], v[136:139]
    v_mfma_f32_16x16x32_bf16 v[140:143], v[160:163], a[216:219], v[140:143]
    ds_read_b64_tr_b16 v[20:21], v233 offset:0
    v_mfma_f32_16x16x32_bf16 v[140:143], v[164:167], a[212:215], v[140:143]
    v_mfma_f32_16x16x32_bf16 v[144:147], v[164:167], a[216:219], v[144:147]
    ds_read_b64_tr_b16 v[24:25], v233 offset:32
    s_waitcnt lgkmcnt(15)
    v_mfma_f32_16x16x32_bf16 v[140:143], v[84:87], a[220:223], v[140:143]
    v_mfma_f32_16x16x32_bf16 v[140:143], v[168:171], a[208:211], v[140:143]
    v_mfma_f32_16x16x32_bf16 v[144:147], v[160:163], a[220:223], v[144:147]
    ds_read_b64 v[38:39], v232 offset:16
    v_mfma_f32_16x16x32_bf16 v[144:147], v[168:171], a[212:215], v[144:147]
    v_mfma_f32_16x16x32_bf16 v[148:151], v[164:167], a[220:223], v[148:151]
    ds_read_b64_tr_b16 v[22:23], v233 offset:1024
    v_mfma_f32_16x16x32_bf16 v[148:151], v[168:171], a[216:219], v[148:151]
    v_mfma_f32_16x16x32_bf16 v[152:155], v[168:171], a[220:223], v[152:155]
    ds_read_b64_tr_b16 v[26:27], v233 offset:1056
    s_waitcnt lgkmcnt(15)
    v_mfma_f32_16x16x32_bf16 v[144:147], v[84:87], a[224:227], v[144:147]
    v_mfma_f32_16x16x32_bf16 v[144:147], v[172:175], a[208:211], v[144:147]
    v_mfma_f32_16x16x32_bf16 v[148:151], v[160:163], a[224:227], v[148:151]
    ds_read_b64 v[40:41], v232 offset:64
    v_mfma_f32_16x16x32_bf16 v[148:151], v[172:175], a[212:215], v[148:151]
    v_mfma_f32_16x16x32_bf16 v[152:155], v[164:167], a[224:227], v[152:155]
    ds_read_b64_tr_b16 v[28:29], v233 offset:2048
    v_mfma_f32_16x16x32_bf16 v[152:155], v[172:175], a[216:219], v[152:155]
    v_mfma_f32_16x16x32_bf16 v[156:159], v[168:171], a[224:227], v[156:159]
    ds_read_b64_tr_b16 v[32:33], v233 offset:2080
    v_mfma_f32_16x16x32_bf16 v[156:159], v[172:175], a[220:223], v[156:159]
    s_waitcnt lgkmcnt(15)
    v_mfma_f32_16x16x32_bf16 v[148:151], v[84:87], a[228:231], v[148:151]
    v_mfma_f32_16x16x32_bf16 v[148:151], v[176:179], a[208:211], v[148:151]
    ds_read_b64 v[42:43], v232 offset:80
    v_mfma_f32_16x16x32_bf16 v[152:155], v[160:163], a[228:231], v[152:155]
    v_mfma_f32_16x16x32_bf16 v[152:155], v[176:179], a[212:215], v[152:155]
    ds_read_b64_tr_b16 v[30:31], v233 offset:3072
    v_mfma_f32_16x16x32_bf16 v[156:159], v[164:167], a[228:231], v[156:159]
    v_mfma_f32_16x16x32_bf16 v[156:159], v[176:179], a[216:219], v[156:159]
    ds_read_b64_tr_b16 v[34:35], v233 offset:3104
    s_waitcnt lgkmcnt(15)
    v_mfma_f32_16x16x32_bf16 v[152:155], v[84:87], a[232:235], v[152:155]
    v_mfma_f32_16x16x32_bf16 v[152:155], v[180:183], a[208:211], v[152:155]
    v_mfma_f32_16x16x32_bf16 v[156:159], v[160:163], a[232:235], v[156:159]
    v_mfma_f32_16x16x32_bf16 v[156:159], v[180:183], a[212:215], v[156:159]
    s_waitcnt lgkmcnt(14)
    v_mfma_f32_16x16x32_bf16 v[156:159], v[84:87], a[236:239], v[156:159]
    s_waitcnt lgkmcnt(12)
    v_mfma_f32_16x16x32_bf16 v[156:159], v[184:187], a[208:211], v[156:159]
    s_waitcnt lgkmcnt(7)
    v_mfma_f32_32x32x16_bf16 v[96:111], v[36:39], v[20:23], 0
    s_waitcnt lgkmcnt(6)
    v_mfma_f32_32x32x16_bf16 v[112:127], v[36:39], v[24:27], 0
    s_waitcnt lgkmcnt(1)
    v_mfma_f32_32x32x16_bf16 v[96:111], v[40:43], v[28:31], v[96:111]
    s_waitcnt lgkmcnt(0)
    v_mfma_f32_32x32x16_bf16 v[112:127], v[40:43], v[32:35], v[112:127]
    s_cmp_ge_u32 s2, 172
    s_cbranch_scc1 Lskip_21
    s_waitcnt vmcnt(13)
    ds_read_b64_tr_b16 v[48:49], v222 offset:0
    ds_read_b64_tr_b16 v[50:51], v222 offset:1024
    ds_read_b64_tr_b16 v[52:53], v222 offset:64
    ds_read_b64_tr_b16 v[54:55], v222 offset:1088
    s_waitcnt lgkmcnt(2)
    buffer_store_dwordx4 v[48:51], v221, s[48:51], s22 offen offset:0 sc1
    s_waitcnt lgkmcnt(0)
    buffer_store_dwordx4 v[52:55], v221, s[48:51], s22 offen offset:1024 sc1
    s_nop 1
Lskip_21:
    ds_read_b128 v[72:75], v229 offset:0
    ds_read_b128 v[76:79], v229 offset:1024
    ds_read_b128 v[80:83], v229 offset:2048
    ds_read_b128 v[84:87], v229 offset:3072
    s_cmp_eq_u32 s77, 0
    s_cbranch_scc0 Lskip_22
    ds_write_b128 v228, v[144:147] offset:0
    ds_write_b128 v228, v[148:151] offset:1024
    ds_write_b128 v228, v[152:155] offset:2048
    ds_write_b128 v228, v[156:159] offset:3072
Lskip_22:
    s_cmp_eq_u32 s77, 1
    s_cbranch_scc0 Lskip_23
    ds_write_b128 v228, v[128:131] offset:0
    ds_write_b128 v228, v[132:135] offset:1024
    ds_write_b128 v228, v[136:139] offset:2048
    ds_write_b128 v228, v[140:143] offset:3072
Lskip_23:
    v_cmp_gt_u32 vcc, 32, v1
    s_nop 1
    v_cndmask_b32 v96, v112, v96, vcc
    v_cndmask_b32 v97, v113, v97, vcc
    ds_write_b64 v226, v[96:97]
    s_waitcnt lgkmcnt(0)
    s_barrier
    s_cmp_lg_u32 s72, 3
    s_cbranch_scc1 Lskip_24
    ds_read_b64 v[20:21], v224 offset:0
    ds_read_b64 v[22:23], v224 offset:512
    ds_read_b64 v[24:25], v224 offset:1024
    ds_read_b64 v[26:27], v224 offset:1536
Lskip_24:
    ds_read_b128 v[48:51], v227 offset:0
    ds_read_b128 v[52:55], v227 offset:1024
    ds_read_b128 v[56:59], v227 offset:2048
    ds_read_b128 v[60:63], v227 offset:3072
    s_cmp_lg_u32 s72, 3
    s_cbranch_scc1 Lskip_25
    s_cmp_ge_u32 s2, 172
    s_cbranch_scc1 Lskip_26
    s_waitcnt lgkmcnt(4)
    v_pk_add_f32 v[20:21], v[20:21], v[22:23]
    s_waitcnt lgkmcnt(4)
    v_pk_add_f32 v[24:25], v[24:25], v[26:27]
    s_waitcnt lgkmcnt(4)
    v_pk_add_f32 v[20:21], v[20:21], v[24:25]
    s_waitcnt lgkmcnt(4)
    v_cvt_pk_bf16_f32 v22, v20, v21
    s_waitcnt lgkmcnt(4)
    v_lshlrev_b32 v24, 16, v22
    s_waitcnt lgkmcnt(4)
    v_and_b32 v25, 0xffff0000, v22
    s_waitcnt lgkmcnt(4)
    v_sub_f32 v24, v20, v24
    s_waitcnt lgkmcnt(4)
    v_sub_f32 v25, v21, v25
    s_waitcnt lgkmcnt(4)
    v_cvt_pk_bf16_f32 v23, v24, v25
    s_waitcnt lgkmcnt(4)
    buffer_store_short v22, v223, s[48:51], s35 offen sc1
    s_waitcnt lgkmcnt(4)
    buffer_store_short v23, v223, s[48:51], s35 offen offset:64 sc1
    s_waitcnt lgkmcnt(4)
    buffer_store_short_d16_hi v22, v223, s[48:51], s35 offen offset:128 sc1
    s_waitcnt lgkmcnt(4)
    buffer_store_short_d16_hi v23, v223, s[48:51], s35 offen offset:192 sc1
Lskip_26:
Lskip_25:
    s_nop 1
    s_cmp_eq_u32 s77, 0
    s_cbranch_scc0 Lskip_27
    s_waitcnt lgkmcnt(3)
    v_pk_add_f32 v[48:49], v[48:49], v[128:129]
    s_waitcnt lgkmcnt(3)
    v_pk_add_f32 v[50:51], v[50:51], v[130:131]
    s_waitcnt lgkmcnt(2)
    v_pk_add_f32 v[52:53], v[52:53], v[132:133]
    s_waitcnt lgkmcnt(2)
    v_pk_add_f32 v[54:55], v[54:55], v[134:135]
    s_waitcnt lgkmcnt(1)
    v_pk_add_f32 v[56:57], v[56:57], v[136:137]
    s_waitcnt lgkmcnt(1)
    v_pk_add_f32 v[58:59], v[58:59], v[138:139]
    s_waitcnt lgkmcnt(0)
    v_pk_add_f32 v[60:61], v[60:61], v[140:141]
    s_waitcnt lgkmcnt(0)
    v_pk_add_f32 v[62:63], v[62:63], v[142:143]
Lskip_27:
    s_cmp_eq_u32 s77, 1
    s_cbranch_scc0 Lskip_28
    s_waitcnt lgkmcnt(3)
    v_pk_add_f32 v[48:49], v[48:49], v[144:145]
    s_waitcnt lgkmcnt(3)
    v_pk_add_f32 v[50:51], v[50:51], v[146:147]
    s_waitcnt lgkmcnt(2)
    v_pk_add_f32 v[52:53], v[52:53], v[148:149]
    s_waitcnt lgkmcnt(2)
    v_pk_add_f32 v[54:55], v[54:55], v[150:151]
    s_waitcnt lgkmcnt(1)
    v_pk_add_f32 v[56:57], v[56:57], v[152:153]
    s_waitcnt lgkmcnt(1)
    v_pk_add_f32 v[58:59], v[58:59], v[154:155]
    s_waitcnt lgkmcnt(0)
    v_pk_add_f32 v[60:61], v[60:61], v[156:157]
    s_waitcnt lgkmcnt(0)
    v_pk_add_f32 v[62:63], v[62:63], v[158:159]
Lskip_28:
    s_waitcnt lgkmcnt(3)
    v_fmac_f32 v72, v12, v48
    v_fmac_f32 v73, v12, v49
    v_fmac_f32 v74, v12, v50
    v_fmac_f32 v75, v12, v51
    s_waitcnt lgkmcnt(2)
    v_fmac_f32 v76, v12, v52
    v_fmac_f32 v77, v12, v53
    v_fmac_f32 v78, v12, v54
    v_fmac_f32 v79, v12, v55
    s_waitcnt lgkmcnt(1)
    v_fmac_f32 v80, v12, v56
    v_fmac_f32 v81, v12, v57
    v_fmac_f32 v82, v12, v58
    v_fmac_f32 v83, v12, v59
    s_waitcnt lgkmcnt(0)
    v_fmac_f32 v84, v12, v60
    v_fmac_f32 v85, v12, v61
    v_fmac_f32 v86, v12, v62
    v_fmac_f32 v87, v12, v63
    v_cvt_pk_bf16_f32 v20, v72, v73
    v_cvt_pk_bf16_f32 v21, v74, v75
    v_cvt_pk_bf16_f32 v22, v76, v77
    v_cvt_pk_bf16_f32 v23, v78, v79
    v_cvt_pk_bf16_f32 v24, v80, v81
    v_cvt_pk_bf16_f32 v25, v82, v83
    v_cvt_pk_bf16_f32 v26, v84, v85
    v_cvt_pk_bf16_f32 v27, v86, v87
    v_permlane16_swap_b32 v20, v22
    v_permlane16_swap_b32 v21, v23
    v_permlane16_swap_b32 v24, v26
    v_permlane16_swap_b32 v25, v27
    buffer_store_dwordx4 v[20:23], v225, s[48:51], s21 offen offset:0 sc1
    buffer_store_dwordx4 v[24:27], v225, s[48:51], s21 offen offset:1024 sc1
    v_lshlrev_b32 v72, 16, v20
    v_and_b32 v73, 0xffff0000, v20
    v_lshlrev_b32 v74, 16, v21
    v_and_b32 v75, 0xffff0000, v21
    v_lshlrev_b32 v76, 16, v22
    v_and_b32 v77, 0xffff0000, v22
    v_lshlrev_b32 v78, 16, v23
    v_and_b32 v79, 0xffff0000, v23
    v_lshlrev_b32 v80, 16, v24
    v_and_b32 v81, 0xffff0000, v24
    v_lshlrev_b32 v82, 16, v25
    v_and_b32 v83, 0xffff0000, v25
    v_lshlrev_b32 v84, 16, v26
    v_and_b32 v85, 0xffff0000, v26
    v_lshlrev_b32 v86, 16, v27
    v_and_b32 v87, 0xffff0000, v27
    v_pk_mul_f32 v[72:73], v[72:73], v[14:15] op_sel_hi:[1,0]
    v_pk_mul_f32 v[74:75], v[74:75], v[14:15] op_sel_hi:[1,0]
    v_pk_mul_f32 v[76:77], v[76:77], v[14:15] op_sel_hi:[1,0]
    v_pk_mul_f32 v[78:79], v[78:79], v[14:15] op_sel_hi:[1,0]
    v_pk_mul_f32 v[80:81], v[80:81], v[14:15] op_sel_hi:[1,0]
    v_pk_mul_f32 v[82:83], v[82:83], v[14:15] op_sel_hi:[1,0]
    v_pk_mul_f32 v[84:85], v[84:85], v[14:15] op_sel_hi:[1,0]
    v_pk_mul_f32 v[86:87], v[86:87], v[14:15] op_sel_hi:[1,0]
    v_cvt_pk_bf16_f32 v28, v72, v73
    v_cvt_pk_bf16_f32 v29, v74, v75
    v_cvt_pk_bf16_f32 v30, v76, v77
    v_cvt_pk_bf16_f32 v31, v78, v79
    v_cvt_pk_bf16_f32 v32, v80, v81
    v_cvt_pk_bf16_f32 v33, v82, v83
    v_cvt_pk_bf16_f32 v34, v84, v85
    v_cvt_pk_bf16_f32 v35, v86, v87
    buffer_store_dwordx4 v[28:31], v225, s[48:51], s20 offen offset:0 sc1
    buffer_store_dwordx4 v[32:35], v225, s[48:51], s20 offen offset:1024 sc1
    s_nop 1
    s_and_b32 s4, s2, 7
    s_lshl_b32 s4, s4, 8
    s_add_u32 s4, s4, 0x00010000
    v_mul_u32_u24 v2, 2048, v1
    v_add_u32 v2, s4, v2
    v_mov_b32 v3, 1
    s_lshr_b32 s4, s2, 0
    s_and_b32 s4, s4, 31
    s_mul_i32 s4, s4, 2048
    s_add_u32 s4, s4, 0x00010000
    v_and_b32 v12, 7, v1
    v_lshl_add_u32 v12, v12, 8, s4
    s_waitcnt vmcnt(0)
    s_waitcnt lgkmcnt(0)
    s_barrier
    s_cmp_lg_u32 s72, 0
    s_cbranch_scc1 Lskip_29
    s_mov_b32 exec_lo, 0xffffffff
    s_mov_b32 exec_hi, 0x0
    buffer_atomic_add v3, v2, s[48:51], 0 offen sc1
    s_mov_b64 exec, -1
Lskip_29:
    s_cmp_lg_u32 s72, 0
    s_cbranch_scc1 Lskip_32
    v_mov_b32 v34, 0
    s_mov_b64 exec, 0xff
    buffer_atomic_add v34, v12, s[48:51], 0 offen sc0 sc1
    s_mov_b64 exec, -1
Lskip_32:
    s_lshl_b32 s4, s25, 8
    s_lshl_b32 s5, s72, 16
    s_add_u32 s4, s4, s5
    s_add_u32 s90, s4, 3145728
    s_add_u32 s91, s4, 3161088
    s_add_u32 s92, s4, 3176448
    s_add_u32 s93, s4, 3191808
    s_lshl_b32 s87, s72, 12
    v_lshrrev_b32 v8, 4, v1
    v_lshlrev_b32 v9, 2, v8
    v_and_b32 v10, 15, v1
    v_xor_b32 v9, v9, v10
    v_lshlrev_b32 v9, 4, v9
    v_lshl_add_u32 v2, v8, 12, v9
    v_lshlrev_b32 v3, 4, v1
    v_bfe_u32 v8, v1, 2, 2
    v_lshrrev_b32 v9, 5, v1
    v_lshl_add_u32 v9, v9, 2, v8
    v_bfe_u32 v10, v1, 4, 1
    v_and_b32 v11, 3, v1
    v_lshlrev_b32 v22, 6, v9
    v_lshl_add_u32 v22, v10, 5, v22
    v_lshl_add_u32 v22, v11, 3, v22
    s_mul_i32 s4, s77, 3072
    s_add_u32 s4, s4, 73984
    v_add_u32 v22, s4, v22
    v_mul_u32_u24 v13, 192, v9
    v_mul_u32_u24 v14, 3104, v10
    v_add_u32 v13, v13, v14
    v_lshl_add_u32 v13, v11, 3, v13
    s_mul_i32 s4, s77, 96
    v_add_u32 v13, s4, v13
    v_add_u32 v14, 133376, v13
    v_add_u32 v15, 0, v13
    v_add_u32 v13, 108544, v13
    s_lshl_b32 s4, s76, 1
    v_xor_b32 v8, s4, v8
    v_lshlrev_b32 v8, 6, v8
    v_lshl_add_u32 v8, v9, 8, v8
    v_lshl_add_u32 v8, v10, 5, v8
    v_lshl_add_u32 v8, v11, 3, v8
    v_xor_b32 v9, 64, v8
    v_add_u32 v16, 24832, v8
    v_add_u32 v17, 24832, v9
    v_add_u32 v18, 41216, v8
    v_add_u32 v19, 41216, v9
    v_add_u32 v20, 57600, v8
    v_add_u32 v21, 57600, v9
    s_lshl_b32 s4, s73, 2
    s_lshr_b32 s5, s74, 3
    s_add_u32 s80, s4, s5
    s_and_b32 s81, s74, 7
    s_mov_b32 s16, 4096
    s_mov_b32 s17, 8192
    s_mov_b32 s30, 12288
    s_mov_b32 s31, 16384
    s_mov_b32 s32, 20480
    v_lshlrev_b32 v23, 4, v1
    s_lshl_b32 s4, s80, 1
    s_add_u32 s5, s4, s77
    s_xor_b32 s6, s5, 1
    s_mul_i32 s5, s5, 88064
    s_mul_i32 s6, s6, 88064
    s_add_u32 s5, s5, 10485760
    s_add_u32 s6, s6, 10485760
    s_mul_i32 s7, s72, 21504
    s_min_u32 s8, s72, 1
    s_add_u32 s8, s8, 84
    s_lshl_b32 s9, s8, 10
    s_add_u32 s4, s5, s7
    v_add_u32 v24, s4, v23
    s_add_u32 s4, s5, s9
    v_add_u32 v26, s4, v23
    s_add_u32 s4, s6, s7
    v_add_u32 v25, s4, v23
    s_add_u32 s4, s6, s9
    v_add_u32 v27, s4, v23
    v_bfe_u32 v9, v1, 2, 2
    v_lshrrev_b32 v10, 5, v1
    v_lshl_add_u32 v9, v10, 2, v9
    v_lshlrev_b32 v9, 6, v9
    v_bfe_u32 v10, v1, 4, 1
    v_lshl_add_u32 v9, v10, 5, v9
    v_and_b32 v10, 3, v1
    v_lshl_add_u32 v9, v10, 3, v9
    s_lshl_b32 s4, s72, 11
    s_add_u32 s4, s4, 57600
    v_add_u32 v28, s4, v9
    v_and_b32 v8, 31, v1
    v_lshlrev_b32 v8, 10, v8
    v_lshrrev_b32 v9, 5, v1
    v_lshl_add_u32 v29, v9, 4, v8
    s_lshl_b32 s4, s80, 16
    s_lshl_b32 s5, s77, 15
    s_add_u32 s4, s4, s5
    s_lshl_b32 s5, s81, 7
    s_add_u32 s4, s4, s5
    s_lshl_b32 s5, s76, 6
    s_add_u32 s33, s4, s5
    s_xor_b32 s4, s72, 1
    s_mul_i32 s4, s4, 12288
    s_add_u32 s4, s4, 80128
    v_add_u32 v30, s4, v23
    s_xor_b32 s4, s72, 2
    s_mul_i32 s4, s4, 12288
    s_add_u32 s4, s4, 84224
    v_add_u32 v31, s4, v23
    s_xor_b32 s4, s72, 3
    s_mul_i32 s4, s4, 12288
    s_add_u32 s4, s4, 88320
    v_add_u32 v32, s4, v23
    s_mul_i32 s4, s72, 12288
    s_add_u32 s4, s4, 80128
    v_add_u32 v33, s4, v23
    s_cmp_lg_u32 s72, 0
    s_cbranch_scc1 Lskip_33
    s_mov_b32 s88, 0
    s_waitcnt vmcnt(0)
    s_mov_b64 exec, 0xff
    v_cmp_gt_u32 vcc, 32, v34
    s_mov_b64 exec, -1
    s_cbranch_vccz Lpolld_31
Lpoll_30:
    s_waitcnt vmcnt(0)
    v_mov_b32 v34, 0
    s_mov_b64 exec, 0xff
    s_waitcnt vmcnt(0)
    buffer_atomic_add v34, v12, s[48:51], 0 offen sc0 sc1
    s_mov_b64 exec, -1
    s_add_u32 s88, s88, 1
    s_waitcnt vmcnt(0)
    s_mov_b64 exec, 0xff
    s_waitcnt vmcnt(0)
    v_cmp_gt_u32 vcc, 32, v34
    s_mov_b64 exec, -1
    s_cmp_gt_u32 s88, 0x40000
    s_cbranch_scc1 Lpolld_31
    s_cbranch_vccnz Lpoll_30
Lpolld_31:
Lskip_33:
    s_waitcnt lgkmcnt(0)
    s_barrier
    s_cmp_lt_u32 s26, 15
    s_cbranch_scc1 Lskip_34
    v_lshrrev_b32 v8, 4, v1
    v_lshlrev_b32 v8, 12, v8
    v_and_b32 v9, 15, v1
    v_lshl_add_u32 v8, v9, 4, v8
    s_lshl_b32 s4, s25, 8
    s_lshl_b32 s5, s72, 19
    s_add_u32 s4, s4, s5
    s_add_u32 s4, s4, 1048576
    buffer_load_dwordx4 v[72:75], v8, s[48:51], s4 offen sc1
    s_add_u32 s4, s4, 16384
    buffer_load_dwordx4 v[76:79], v8, s[48:51], s4 offen sc1
    s_add_u32 s4, s4, 16384
    buffer_load_dwordx4 v[80:83], v8, s[48:51], s4 offen sc1
    s_add_u32 s4, s4, 16384
    buffer_load_dwordx4 v[84:87], v8, s[48:51], s4 offen sc1
    s_add_u32 s4, s4, 16384
    buffer_load_dwordx4 v[88:91], v8, s[48:51], s4 offen sc1
    s_add_u32 s4, s4, 16384
    buffer_load_dwordx4 v[92:95], v8, s[48:51], s4 offen sc1
    s_add_u32 s4, s4, 16384
    buffer_load_dwordx4 v[96:99], v8, s[48:51], s4 offen sc1
    s_add_u32 s4, s4, 16384
    buffer_load_dwordx4 v[100:103], v8, s[48:51], s4 offen sc1
    s_add_u32 s4, s4, 16384
    buffer_load_dwordx4 v[104:107], v8, s[48:51], s4 offen sc1
    s_add_u32 s4, s4, 16384
    buffer_load_dwordx4 v[108:111], v8, s[48:51], s4 offen sc1
    s_add_u32 s4, s4, 16384
    buffer_load_dwordx4 v[112:115], v8, s[48:51], s4 offen sc1
    s_add_u32 s4, s4, 16384
    buffer_load_dwordx4 v[116:119], v8, s[48:51], s4 offen sc1
    s_add_u32 s4, s4, 16384
    buffer_load_dwordx4 v[120:123], v8, s[48:51], s4 offen sc1
    s_add_u32 s4, s4, 16384
    buffer_load_dwordx4 v[124:127], v8, s[48:51], s4 offen sc1
    s_add_u32 s4, s4, 16384
    buffer_load_dwordx4 v[128:131], v8, s[48:51], s4 offen sc1
    s_add_u32 s4, s4, 16384
    buffer_load_dwordx4 v[132:135], v8, s[48:51], s4 offen sc1
    s_add_u32 s4, s4, 16384
    buffer_load_dwordx4 v[136:139], v8, s[48:51], s4 offen sc1
    s_add_u32 s4, s4, 16384
    buffer_load_dwordx4 v[140:143], v8, s[48:51], s4 offen sc1
    s_add_u32 s4, s4, 16384
    buffer_load_dwordx4 v[144:147], v8, s[48:51], s4 offen sc1
    s_add_u32 s4, s4, 16384
    buffer_load_dwordx4 v[148:151], v8, s[48:51], s4 offen sc1
    s_add_u32 s4, s4, 16384
    buffer_load_dwordx4 v[152:155], v8, s[48:51], s4 offen sc1
    s_add_u32 s4, s4, 16384
    buffer_load_dwordx4 v[156:159], v8, s[48:51], s4 offen sc1
    s_add_u32 s4, s4, 16384
    buffer_load_dwordx4 v[160:163], v8, s[48:51], s4 offen sc1
    s_add_u32 s4, s4, 16384
    buffer_load_dwordx4 v[164:167], v8, s[48:51], s4 offen sc1
    s_add_u32 s4, s4, 16384
    buffer_load_dwordx4 v[168:171], v8, s[48:51], s4 offen sc1
    s_add_u32 s4, s4, 16384
    buffer_load_dwordx4 v[172:175], v8, s[48:51], s4 offen sc1
    s_add_u32 s4, s4, 16384
    buffer_load_dwordx4 v[176:179], v8, s[48:51], s4 offen sc1
    s_add_u32 s4, s4, 16384
    buffer_load_dwordx4 v[180:183], v8, s[48:51], s4 offen sc1
    s_add_u32 s4, s4, 16384
    buffer_load_dwordx4 v[184:187], v8, s[48:51], s4 offen sc1
    s_add_u32 s4, s4, 16384
    buffer_load_dwordx4 v[188:191], v8, s[48:51], s4 offen sc1
    s_add_u32 s4, s4, 16384
    buffer_load_dwordx4 v[192:195], v8, s[48:51], s4 offen sc1
    s_add_u32 s4, s4, 16384
    buffer_load_dwordx4 v[196:199], v8, s[48:51], s4 offen sc1
    v_mov_b32 v10, 0x3f803f80
    s_mov_b32 s6, 0x05040100
    s_mov_b32 s7, 0x07060302
    s_waitcnt vmcnt(30)
    v_perm_b32 v56, v76, v72, s6
    v_perm_b32 v57, v76, v72, s7
    v_perm_b32 v58, v77, v73, s6
    v_perm_b32 v59, v77, v73, s7
    v_perm_b32 v60, v78, v74, s6
    v_perm_b32 v61, v78, v74, s7
    v_perm_b32 v62, v79, v75, s6
    v_perm_b32 v63, v79, v75, s7
    v_dot2_f32_bf16 v40, v56, v10, 0
    v_dot2_f32_bf16 v41, v57, v10, 0
    v_dot2_f32_bf16 v42, v58, v10, 0
    v_dot2_f32_bf16 v43, v59, v10, 0
    v_dot2_f32_bf16 v44, v60, v10, 0
    v_dot2_f32_bf16 v45, v61, v10, 0
    v_dot2_f32_bf16 v46, v62, v10, 0
    v_dot2_f32_bf16 v47, v63, v10, 0
    v_dot2_f32_bf16 v48, v56, v56, 0
    v_dot2_f32_bf16 v49, v57, v57, 0
    v_dot2_f32_bf16 v50, v58, v58, 0
    v_dot2_f32_bf16 v51, v59, v59, 0
    v_dot2_f32_bf16 v52, v60, v60, 0
    v_dot2_f32_bf16 v53, v61, v61, 0
    v_dot2_f32_bf16 v54, v62, v62, 0
    v_dot2_f32_bf16 v55, v63, v63, 0
    s_waitcnt vmcnt(28)
    v_perm_b32 v56, v84, v80, s6
    v_perm_b32 v57, v84, v80, s7
    v_perm_b32 v58, v85, v81, s6
    v_perm_b32 v59, v85, v81, s7
    v_perm_b32 v60, v86, v82, s6
    v_perm_b32 v61, v86, v82, s7
    v_perm_b32 v62, v87, v83, s6
    v_perm_b32 v63, v87, v83, s7
    v_dot2c_f32_bf16 v40, v56, v10
    v_dot2c_f32_bf16 v41, v57, v10
    v_dot2c_f32_bf16 v42, v58, v10
    v_dot2c_f32_bf16 v43, v59, v10
    v_dot2c_f32_bf16 v44, v60, v10
    v_dot2c_f32_bf16 v45, v61, v10
    v_dot2c_f32_bf16 v46, v62, v10
    v_dot2c_f32_bf16 v47, v63, v10
    v_dot2c_f32_bf16 v48, v56, v56
    v_dot2c_f32_bf16 v49, v57, v57
    v_dot2c_f32_bf16 v50, v58, v58
    v_dot2c_f32_bf16 v51, v59, v59
    v_dot2c_f32_bf16 v52, v60, v60
    v_dot2c_f32_bf16 v53, v61, v61
    v_dot2c_f32_bf16 v54, v62, v62
    v_dot2c_f32_bf16 v55, v63, v63
    s_waitcnt vmcnt(26)
    v_perm_b32 v56, v92, v88, s6
    v_perm_b32 v57, v92, v88, s7
    v_perm_b32 v58, v93, v89, s6
    v_perm_b32 v59, v93, v89, s7
    v_perm_b32 v60, v94, v90, s6
    v_perm_b32 v61, v94, v90, s7
    v_perm_b32 v62, v95, v91, s6
    v_perm_b32 v63, v95, v91, s7
    v_dot2c_f32_bf16 v40, v56, v10
    v_dot2c_f32_bf16 v41, v57, v10
    v_dot2c_f32_bf16 v42, v58, v10
    v_dot2c_f32_bf16 v43, v59, v10
    v_dot2c_f32_bf16 v44, v60, v10
    v_dot2c_f32_bf16 v45, v61, v10
    v_dot2c_f32_bf16 v46, v62, v10
    v_dot2c_f32_bf16 v47, v63, v10
    v_dot2c_f32_bf16 v48, v56, v56
    v_dot2c_f32_bf16 v49, v57, v57
    v_dot2c_f32_bf16 v50, v58, v58
    v_dot2c_f32_bf16 v51, v59, v59
    v_dot2c_f32_bf16 v52, v60, v60
    v_dot2c_f32_bf16 v53, v61, v61
    v_dot2c_f32_bf16 v54, v62, v62
    v_dot2c_f32_bf16 v55, v63, v63
    s_waitcnt vmcnt(24)
    v_perm_b32 v56, v100, v96, s6
    v_perm_b32 v57, v100, v96, s7
    v_perm_b32 v58, v101, v97, s6
    v_perm_b32 v59, v101, v97, s7
    v_perm_b32 v60, v102, v98, s6
    v_perm_b32 v61, v102, v98, s7
    v_perm_b32 v62, v103, v99, s6
    v_perm_b32 v63, v103, v99, s7
    v_dot2c_f32_bf16 v40, v56, v10
    v_dot2c_f32_bf16 v41, v57, v10
    v_dot2c_f32_bf16 v42, v58, v10
    v_dot2c_f32_bf16 v43, v59, v10
    v_dot2c_f32_bf16 v44, v60, v10
    v_dot2c_f32_bf16 v45, v61, v10
    v_dot2c_f32_bf16 v46, v62, v10
    v_dot2c_f32_bf16 v47, v63, v10
    v_dot2c_f32_bf16 v48, v56, v56
    v_dot2c_f32_bf16 v49, v57, v57
    v_dot2c_f32_bf16 v50, v58, v58
    v_dot2c_f32_bf16 v51, v59, v59
    v_dot2c_f32_bf16 v52, v60, v60
    v_dot2c_f32_bf16 v53, v61, v61
    v_dot2c_f32_bf16 v54, v62, v62
    v_dot2c_f32_bf16 v55, v63, v63
    s_waitcnt vmcnt(22)
    v_perm_b32 v56, v108, v104, s6
    v_perm_b32 v57, v108, v104, s7
    v_perm_b32 v58, v109, v105, s6
    v_perm_b32 v59, v109, v105, s7
    v_perm_b32 v60, v110, v106, s6
    v_perm_b32 v61, v110, v106, s7
    v_perm_b32 v62, v111, v107, s6
    v_perm_b32 v63, v111, v107, s7
    v_dot2c_f32_bf16 v40, v56, v10
    v_dot2c_f32_bf16 v41, v57, v10
    v_dot2c_f32_bf16 v42, v58, v10
    v_dot2c_f32_bf16 v43, v59, v10
    v_dot2c_f32_bf16 v44, v60, v10
    v_dot2c_f32_bf16 v45, v61, v10
    v_dot2c_f32_bf16 v46, v62, v10
    v_dot2c_f32_bf16 v47, v63, v10
    v_dot2c_f32_bf16 v48, v56, v56
    v_dot2c_f32_bf16 v49, v57, v57
    v_dot2c_f32_bf16 v50, v58, v58
    v_dot2c_f32_bf16 v51, v59, v59
    v_dot2c_f32_bf16 v52, v60, v60
    v_dot2c_f32_bf16 v53, v61, v61
    v_dot2c_f32_bf16 v54, v62, v62
    v_dot2c_f32_bf16 v55, v63, v63
    s_waitcnt vmcnt(20)
    v_perm_b32 v56, v116, v112, s6
    v_perm_b32 v57, v116, v112, s7
    v_perm_b32 v58, v117, v113, s6
    v_perm_b32 v59, v117, v113, s7
    v_perm_b32 v60, v118, v114, s6
    v_perm_b32 v61, v118, v114, s7
    v_perm_b32 v62, v119, v115, s6
    v_perm_b32 v63, v119, v115, s7
    v_dot2c_f32_bf16 v40, v56, v10
    v_dot2c_f32_bf16 v41, v57, v10
    v_dot2c_f32_bf16 v42, v58, v10
    v_dot2c_f32_bf16 v43, v59, v10
    v_dot2c_f32_bf16 v44, v60, v10
    v_dot2c_f32_bf16 v45, v61, v10
    v_dot2c_f32_bf16 v46, v62, v10
    v_dot2c_f32_bf16 v47, v63, v10
    v_dot2c_f32_bf16 v48, v56, v56
    v_dot2c_f32_bf16 v49, v57, v57
    v_dot2c_f32_bf16 v50, v58, v58
    v_dot2c_f32_bf16 v51, v59, v59
    v_dot2c_f32_bf16 v52, v60, v60
    v_dot2c_f32_bf16 v53, v61, v61
    v_dot2c_f32_bf16 v54, v62, v62
    v_dot2c_f32_bf16 v55, v63, v63
    s_waitcnt vmcnt(18)
    v_perm_b32 v56, v124, v120, s6
    v_perm_b32 v57, v124, v120, s7
    v_perm_b32 v58, v125, v121, s6
    v_perm_b32 v59, v125, v121, s7
    v_perm_b32 v60, v126, v122, s6
    v_perm_b32 v61, v126, v122, s7
    v_perm_b32 v62, v127, v123, s6
    v_perm_b32 v63, v127, v123, s7
    v_dot2c_f32_bf16 v40, v56, v10
    v_dot2c_f32_bf16 v41, v57, v10
    v_dot2c_f32_bf16 v42, v58, v10
    v_dot2c_f32_bf16 v43, v59, v10
    v_dot2c_f32_bf16 v44, v60, v10
    v_dot2c_f32_bf16 v45, v61, v10
    v_dot2c_f32_bf16 v46, v62, v10
    v_dot2c_f32_bf16 v47, v63, v10
    v_dot2c_f32_bf16 v48, v56, v56
    v_dot2c_f32_bf16 v49, v57, v57
    v_dot2c_f32_bf16 v50, v58, v58
    v_dot2c_f32_bf16 v51, v59, v59
    v_dot2c_f32_bf16 v52, v60, v60
    v_dot2c_f32_bf16 v53, v61, v61
    v_dot2c_f32_bf16 v54, v62, v62
    v_dot2c_f32_bf16 v55, v63, v63
    s_waitcnt vmcnt(16)
    v_perm_b32 v56, v132, v128, s6
    v_perm_b32 v57, v132, v128, s7
    v_perm_b32 v58, v133, v129, s6
    v_perm_b32 v59, v133, v129, s7
    v_perm_b32 v60, v134, v130, s6
    v_perm_b32 v61, v134, v130, s7
    v_perm_b32 v62, v135, v131, s6
    v_perm_b32 v63, v135, v131, s7
    v_dot2c_f32_bf16 v40, v56, v10
    v_dot2c_f32_bf16 v41, v57, v10
    v_dot2c_f32_bf16 v42, v58, v10
    v_dot2c_f32_bf16 v43, v59, v10
    v_dot2c_f32_bf16 v44, v60, v10
    v_dot2c_f32_bf16 v45, v61, v10
    v_dot2c_f32_bf16 v46, v62, v10
    v_dot2c_f32_bf16 v47, v63, v10
    v_dot2c_f32_bf16 v48, v56, v56
    v_dot2c_f32_bf16 v49, v57, v57
    v_dot2c_f32_bf16 v50, v58, v58
    v_dot2c_f32_bf16 v51, v59, v59
    v_dot2c_f32_bf16 v52, v60, v60
    v_dot2c_f32_bf16 v53, v61, v61
    v_dot2c_f32_bf16 v54, v62, v62
    v_dot2c_f32_bf16 v55, v63, v63
    s_waitcnt vmcnt(14)
    v_perm_b32 v56, v140, v136, s6
    v_perm_b32 v57, v140, v136, s7
    v_perm_b32 v58, v141, v137, s6
    v_perm_b32 v59, v141, v137, s7
    v_perm_b32 v60, v142, v138, s6
    v_perm_b32 v61, v142, v138, s7
    v_perm_b32 v62, v143, v139, s6
    v_perm_b32 v63, v143, v139, s7
    v_dot2c_f32_bf16 v40, v56, v10
    v_dot2c_f32_bf16 v41, v57, v10
    v_dot2c_f32_bf16 v42, v58, v10
    v_dot2c_f32_bf16 v43, v59, v10
    v_dot2c_f32_bf16 v44, v60, v10
    v_dot2c_f32_bf16 v45, v61, v10
    v_dot2c_f32_bf16 v46, v62, v10
    v_dot2c_f32_bf16 v47, v63, v10
    v_dot2c_f32_bf16 v48, v56, v56
    v_dot2c_f32_bf16 v49, v57, v57
    v_dot2c_f32_bf16 v50, v58, v58
    v_dot2c_f32_bf16 v51, v59, v59
    v_dot2c_f32_bf16 v52, v60, v60
    v_dot2c_f32_bf16 v53, v61, v61
    v_dot2c_f32_bf16 v54, v62, v62
    v_dot2c_f32_bf16 v55, v63, v63
    s_waitcnt vmcnt(12)
    v_perm_b32 v56, v148, v144, s6
    v_perm_b32 v57, v148, v144, s7
    v_perm_b32 v58, v149, v145, s6
    v_perm_b32 v59, v149, v145, s7
    v_perm_b32 v60, v150, v146, s6
    v_perm_b32 v61, v150, v146, s7
    v_perm_b32 v62, v151, v147, s6
    v_perm_b32 v63, v151, v147, s7
    v_dot2c_f32_bf16 v40, v56, v10
    v_dot2c_f32_bf16 v41, v57, v10
    v_dot2c_f32_bf16 v42, v58, v10
    v_dot2c_f32_bf16 v43, v59, v10
    v_dot2c_f32_bf16 v44, v60, v10
    v_dot2c_f32_bf16 v45, v61, v10
    v_dot2c_f32_bf16 v46, v62, v10
    v_dot2c_f32_bf16 v47, v63, v10
    v_dot2c_f32_bf16 v48, v56, v56
    v_dot2c_f32_bf16 v49, v57, v57
    v_dot2c_f32_bf16 v50, v58, v58
    v_dot2c_f32_bf16 v51, v59, v59
    v_dot2c_f32_bf16 v52, v60, v60
    v_dot2c_f32_bf16 v53, v61, v61
    v_dot2c_f32_bf16 v54, v62, v62
    v_dot2c_f32_bf16 v55, v63, v63
    s_waitcnt vmcnt(10)
    v_perm_b32 v56, v156, v152, s6
    v_perm_b32 v57, v156, v152, s7
    v_perm_b32 v58, v157, v153, s6
    v_perm_b32 v59, v157, v153, s7
    v_perm_b32 v60, v158, v154, s6
    v_perm_b32 v61, v158, v154, s7
    v_perm_b32 v62, v159, v155, s6
    v_perm_b32 v63, v159, v155, s7
    v_dot2c_f32_bf16 v40, v56, v10
    v_dot2c_f32_bf16 v41, v57, v10
    v_dot2c_f32_bf16 v42, v58, v10
    v_dot2c_f32_bf16 v43, v59, v10
    v_dot2c_f32_bf16 v44, v60, v10
    v_dot2c_f32_bf16 v45, v61, v10
    v_dot2c_f32_bf16 v46, v62, v10
    v_dot2c_f32_bf16 v47, v63, v10
    v_dot2c_f32_bf16 v48, v56, v56
    v_dot2c_f32_bf16 v49, v57, v57
    v_dot2c_f32_bf16 v50, v58, v58
    v_dot2c_f32_bf16 v51, v59, v59
    v_dot2c_f32_bf16 v52, v60, v60
    v_dot2c_f32_bf16 v53, v61, v61
    v_dot2c_f32_bf16 v54, v62, v62
    v_dot2c_f32_bf16 v55, v63, v63
    s_waitcnt vmcnt(8)
    v_perm_b32 v56, v164, v160, s6
    v_perm_b32 v57, v164, v160, s7
    v_perm_b32 v58, v165, v161, s6
    v_perm_b32 v59, v165, v161, s7
    v_perm_b32 v60, v166, v162, s6
    v_perm_b32 v61, v166, v162, s7
    v_perm_b32 v62, v167, v163, s6
    v_perm_b32 v63, v167, v163, s7
    v_dot2c_f32_bf16 v40, v56, v10
    v_dot2c_f32_bf16 v41, v57, v10
    v_dot2c_f32_bf16 v42, v58, v10
    v_dot2c_f32_bf16 v43, v59, v10
    v_dot2c_f32_bf16 v44, v60, v10
    v_dot2c_f32_bf16 v45, v61, v10
    v_dot2c_f32_bf16 v46, v62, v10
    v_dot2c_f32_bf16 v47, v63, v10
    v_dot2c_f32_bf16 v48, v56, v56
    v_dot2c_f32_bf16 v49, v57, v57
    v_dot2c_f32_bf16 v50, v58, v58
    v_dot2c_f32_bf16 v51, v59, v59
    v_dot2c_f32_bf16 v52, v60, v60
    v_dot2c_f32_bf16 v53, v61, v61
    v_dot2c_f32_bf16 v54, v62, v62
    v_dot2c_f32_bf16 v55, v63, v63
    s_waitcnt vmcnt(6)
    v_perm_b32 v56, v172, v168, s6
    v_perm_b32 v57, v172, v168, s7
    v_perm_b32 v58, v173, v169, s6
    v_perm_b32 v59, v173, v169, s7
    v_perm_b32 v60, v174, v170, s6
    v_perm_b32 v61, v174, v170, s7
    v_perm_b32 v62, v175, v171, s6
    v_perm_b32 v63, v175, v171, s7
    v_dot2c_f32_bf16 v40, v56, v10
    v_dot2c_f32_bf16 v41, v57, v10
    v_dot2c_f32_bf16 v42, v58, v10
    v_dot2c_f32_bf16 v43, v59, v10
    v_dot2c_f32_bf16 v44, v60, v10
    v_dot2c_f32_bf16 v45, v61, v10
    v_dot2c_f32_bf16 v46, v62, v10
    v_dot2c_f32_bf16 v47, v63, v10
    v_dot2c_f32_bf16 v48, v56, v56
    v_dot2c_f32_bf16 v49, v57, v57
    v_dot2c_f32_bf16 v50, v58, v58
    v_dot2c_f32_bf16 v51, v59, v59
    v_dot2c_f32_bf16 v52, v60, v60
    v_dot2c_f32_bf16 v53, v61, v61
    v_dot2c_f32_bf16 v54, v62, v62
    v_dot2c_f32_bf16 v55, v63, v63
    s_waitcnt vmcnt(4)
    v_perm_b32 v56, v180, v176, s6
    v_perm_b32 v57, v180, v176, s7
    v_perm_b32 v58, v181, v177, s6
    v_perm_b32 v59, v181, v177, s7
    v_perm_b32 v60, v182, v178, s6
    v_perm_b32 v61, v182, v178, s7
    v_perm_b32 v62, v183, v179, s6
    v_perm_b32 v63, v183, v179, s7
    v_dot2c_f32_bf16 v40, v56, v10
    v_dot2c_f32_bf16 v41, v57, v10
    v_dot2c_f32_bf16 v42, v58, v10
    v_dot2c_f32_bf16 v43, v59, v10
    v_dot2c_f32_bf16 v44, v60, v10
    v_dot2c_f32_bf16 v45, v61, v10
    v_dot2c_f32_bf16 v46, v62, v10
    v_dot2c_f32_bf16 v47, v63, v10
    v_dot2c_f32_bf16 v48, v56, v56
    v_dot2c_f32_bf16 v49, v57, v57
    v_dot2c_f32_bf16 v50, v58, v58
    v_dot2c_f32_bf16 v51, v59, v59
    v_dot2c_f32_bf16 v52, v60, v60
    v_dot2c_f32_bf16 v53, v61, v61
    v_dot2c_f32_bf16 v54, v62, v62
    v_dot2c_f32_bf16 v55, v63, v63
    s_waitcnt vmcnt(2)
    v_perm_b32 v56, v188, v184, s6
    v_perm_b32 v57, v188, v184, s7
    v_perm_b32 v58, v189, v185, s6
    v_perm_b32 v59, v189, v185, s7
    v_perm_b32 v60, v190, v186, s6
    v_perm_b32 v61, v190, v186, s7
    v_perm_b32 v62, v191, v187, s6
    v_perm_b32 v63, v191, v187, s7
    v_dot2c_f32_bf16 v40, v56, v10
    v_dot2c_f32_bf16 v41, v57, v10
    v_dot2c_f32_bf16 v42, v58, v10
    v_dot2c_f32_bf16 v43, v59, v10
    v_dot2c_f32_bf16 v44, v60, v10
    v_dot2c_f32_bf16 v45, v61, v10
    v_dot2c_f32_bf16 v46, v62, v10
    v_dot2c_f32_bf16 v47, v63, v10
    v_dot2c_f32_bf16 v48, v56, v56
    v_dot2c_f32_bf16 v49, v57, v57
    v_dot2c_f32_bf16 v50, v58, v58
    v_dot2c_f32_bf16 v51, v59, v59
    v_dot2c_f32_bf16 v52, v60, v60
    v_dot2c_f32_bf16 v53, v61, v61
    v_dot2c_f32_bf16 v54, v62, v62
    v_dot2c_f32_bf16 v55, v63, v63
    s_waitcnt vmcnt(0)
    v_perm_b32 v56, v196, v192, s6
    v_perm_b32 v57, v196, v192, s7
    v_perm_b32 v58, v197, v193, s6
    v_perm_b32 v59, v197, v193, s7
    v_perm_b32 v60, v198, v194, s6
    v_perm_b32 v61, v198, v194, s7
    v_perm_b32 v62, v199, v195, s6
    v_perm_b32 v63, v199, v195, s7
    v_dot2c_f32_bf16 v40, v56, v10
    v_dot2c_f32_bf16 v41, v57, v10
    v_dot2c_f32_bf16 v42, v58, v10
    v_dot2c_f32_bf16 v43, v59, v10
    v_dot2c_f32_bf16 v44, v60, v10
    v_dot2c_f32_bf16 v45, v61, v10
    v_dot2c_f32_bf16 v46, v62, v10
    v_dot2c_f32_bf16 v47, v63, v10
    v_dot2c_f32_bf16 v48, v56, v56
    v_dot2c_f32_bf16 v49, v57, v57
    v_dot2c_f32_bf16 v50, v58, v58
    v_dot2c_f32_bf16 v51, v59, v59
    v_dot2c_f32_bf16 v52, v60, v60
    v_dot2c_f32_bf16 v53, v61, v61
    v_dot2c_f32_bf16 v54, v62, v62
    v_dot2c_f32_bf16 v55, v63, v63
    v_permlane32_swap_b32 v40, v48
    v_permlane32_swap_b32 v41, v49
    v_permlane32_swap_b32 v42, v50
    v_permlane32_swap_b32 v43, v51
    v_permlane32_swap_b32 v44, v52
    v_permlane32_swap_b32 v45, v53
    v_permlane32_swap_b32 v46, v54
    v_permlane32_swap_b32 v47, v55
    v_add_f32 v40, v40, v48
    v_add_f32 v41, v41, v49
    v_add_f32 v42, v42, v50
    v_add_f32 v43, v43, v51
    v_add_f32 v44, v44, v52
    v_add_f32 v45, v45, v53
    v_add_f32 v46, v46, v54
    v_add_f32 v47, v47, v55
    v_permlane16_swap_b32 v40, v44
    v_permlane16_swap_b32 v41, v45
    v_permlane16_swap_b32 v42, v46
    v_permlane16_swap_b32 v43, v47
    v_add_f32 v40, v40, v44
    v_add_f32 v41, v41, v45
    v_add_f32 v42, v42, v46
    v_add_f32 v43, v43, v47
    v_lshrrev_b32 v8, 5, v1
    v_lshlrev_b32 v8, 9, v8
    v_lshl_add_u32 v8, v9, 5, v8
    v_bfe_u32 v9, v1, 4, 1
    v_lshl_add_u32 v8, v9, 4, v8
    s_lshl_b32 s4, s72, 10
    s_add_u32 s4, s4, 80128
    v_add_u32 v8, s4, v8
    ds_write_b128 v8, v[40:43]
    v_and_b32 v9, 127, v0
    v_lshlrev_b32 v8, 2, v9
    v_add_u32 v8, 80128, v8
    s_waitcnt lgkmcnt(0)
    s_barrier
    s_cmp_ge_u32 s72, 2
    s_cbranch_scc1 Lskip_35
    ds_read_b32 v72, v8 offset:0
    ds_read_b32 v76, v8 offset:512
    ds_read_b32 v73, v8 offset:1024
    ds_read_b32 v77, v8 offset:1536
    ds_read_b32 v74, v8 offset:2048
    ds_read_b32 v78, v8 offset:2560
    ds_read_b32 v75, v8 offset:3072
    ds_read_b32 v79, v8 offset:3584
    s_lshl_b32 s4, s25, 10
    s_add_u32 s4, s4, 360448
    v_lshl_add_u32 v9, v9, 3, s4
    v_mov_b32 v81, s100
    s_waitcnt lgkmcnt(5)
    v_add_f32 v72, v72, v73
    s_waitcnt lgkmcnt(4)
    v_add_f32 v76, v76, v77
    s_waitcnt lgkmcnt(1)
    v_add_f32 v74, v74, v75
    s_waitcnt lgkmcnt(0)
    v_add_f32 v78, v78, v79
    v_add_f32 v72, v72, v74
    v_add_f32 v76, v76, v78
    v_mul_f32 v72, 0x3b000000, v72
    v_mul_f32 v76, 0x3b000000, v76
    v_fma_f32 v76, -v72, v72, v76
    v_max_f32 v76, 0, v76
    v_cvt_pk_bf16_f32 v76, v76, v76
    v_lshlrev_b32 v76, 16, v76
    v_add_f32 v76, 0x3727c5ac, v76
    v_cvt_pk_bf16_f32 v76, v76, v76
    v_lshlrev_b32 v76, 16, v76
    v_sqrt_f32 v76, v76
    s_nop 0
    v_cvt_pk_bf16_f32 v80, -v72, v76
    buffer_store_dwordx2 v[80:81], v9, s[48:51], 0 offen sc1
Lskip_35:
    s_nop 1
    s_mov_b32 s89, 0
    buffer_load_dwordx4 a[0:3], v244, s[48:51], s89 offen offset:0 sc1
    buffer_load_dwordx4 a[4:7], v243, s[48:51], s89 offen offset:0 sc1
    s_mov_b32 s89, 4096
    buffer_load_dwordx4 a[8:11], v244, s[48:51], s89 offen offset:2048 sc1
    buffer_load_dwordx4 a[12:15], v243, s[48:51], s89 offen offset:2048 sc1
    s_mov_b32 s89, 12288
    buffer_load_dwordx4 a[16:19], v244, s[48:51], s89 offen offset:0 sc1
    buffer_load_dwordx4 a[20:23], v243, s[48:51], s89 offen offset:0 sc1
    s_mov_b32 s89, 16384
    buffer_load_dwordx4 a[24:27], v244, s[48:51], s89 offen offset:2048 sc1
    buffer_load_dwordx4 a[28:31], v243, s[48:51], s89 offen offset:2048 sc1
    s_mov_b32 s89, 24576
    buffer_load_dwordx4 a[32:35], v244, s[48:51], s89 offen offset:0 sc1
    buffer_load_dwordx4 a[36:39], v243, s[48:51], s89 offen offset:0 sc1
    s_mov_b32 s89, 28672
    buffer_load_dwordx4 a[40:43], v244, s[48:51], s89 offen offset:2048 sc1
    buffer_load_dwordx4 a[44:47], v243, s[48:51], s89 offen offset:2048 sc1
    s_mov_b32 s89, 36864
    buffer_load_dwordx4 a[48:51], v244, s[48:51], s89 offen offset:0 sc1
    buffer_load_dwordx4 a[52:55], v243, s[48:51], s89 offen offset:0 sc1
    s_mov_b32 s89, 0
    buffer_load_dwordx4 a[56:59], v244, s[48:51], s89 offen offset:2048 sc1
    buffer_load_dwordx4 a[60:63], v243, s[48:51], s89 offen offset:2048 sc1
    s_mov_b32 s89, 8192
    buffer_load_dwordx4 a[64:67], v244, s[48:51], s89 offen offset:0 sc1
    buffer_load_dwordx4 a[68:71], v243, s[48:51], s89 offen offset:0 sc1
    s_mov_b32 s89, 12288
    buffer_load_dwordx4 a[72:75], v244, s[48:51], s89 offen offset:2048 sc1
    buffer_load_dwordx4 a[76:79], v243, s[48:51], s89 offen offset:2048 sc1
    s_mov_b32 s89, 20480
    buffer_load_dwordx4 a[80:83], v244, s[48:51], s89 offen offset:0 sc1
    buffer_load_dwordx4 a[84:87], v243, s[48:51], s89 offen offset:0 sc1
    s_mov_b32 s89, 24576
    buffer_load_dwordx4 a[88:91], v244, s[48:51], s89 offen offset:2048 sc1
    buffer_load_dwordx4 a[92:95], v243, s[48:51], s89 offen offset:2048 sc1
    s_mov_b32 s89, 32768
    buffer_load_dwordx4 a[96:99], v244, s[48:51], s89 offen offset:0 sc1
    buffer_load_dwordx4 a[100:103], v243, s[48:51], s89 offen offset:0 sc1
    s_mov_b32 s89, 36864
    buffer_load_dwordx4 a[104:107], v244, s[48:51], s89 offen offset:2048 sc1
    buffer_load_dwordx4 a[108:111], v243, s[48:51], s89 offen offset:2048 sc1
    s_mov_b32 s89, 4096
    buffer_load_dwordx4 a[112:115], v244, s[48:51], s89 offen offset:0 sc1
    buffer_load_dwordx4 a[116:119], v243, s[48:51], s89 offen offset:0 sc1
    s_mov_b32 s89, 8192
    buffer_load_dwordx4 a[120:123], v244, s[48:51], s89 offen offset:2048 sc1
    buffer_load_dwordx4 a[124:127], v243, s[48:51], s89 offen offset:2048 sc1
    s_mov_b32 s89, 16384
    buffer_load_dwordx4 a[128:131], v244, s[48:51], s89 offen offset:0 sc1
    buffer_load_dwordx4 a[132:135], v243, s[48:51], s89 offen offset:0 sc1
    s_mov_b32 s89, 20480
    buffer_load_dwordx4 a[136:139], v244, s[48:51], s89 offen offset:2048 sc1
    buffer_load_dwordx4 a[140:143], v243, s[48:51], s89 offen offset:2048 sc1
    s_mov_b32 s89, 28672
    buffer_load_dwordx4 a[144:147], v244, s[48:51], s89 offen offset:0 sc1
    buffer_load_dwordx4 a[148:151], v243, s[48:51], s89 offen offset:0 sc1
    s_mov_b32 s89, 32768
    buffer_load_dwordx4 a[152:155], v244, s[48:51], s89 offen offset:2048 sc1
    buffer_load_dwordx4 a[156:159], v243, s[48:51], s89 offen offset:2048 sc1
    s_mov_b32 s89, 40960
    buffer_load_dwordx4 a[160:163], v244, s[48:51], s89 offen offset:0 sc1
    buffer_load_dwordx4 a[164:167], v243, s[48:51], s89 offen offset:0 sc1
    buffer_load_dwordx4 a[168:171], v244, s[48:51], s34 offen offset:0 sc1
    buffer_load_dwordx4 a[172:175], v243, s[48:51], s34 offen offset:0 sc1
    s_lshl_b32 s4, s81, 6
    s_lshl_b32 s5, s76, 5
    s_add_u32 s4, s4, s5
    s_lshl_b32 s4, s4, 12
    s_lshl_b32 s5, s80, 7
    s_add_u32 s4, s4, s5
    s_lshl_b32 s5, s77, 6
    s_add_u32 s4, s4, s5
    s_add_u32 s4, s4, 1048576
    v_lshrrev_b32 v8, 2, v1
    v_and_b32 v9, 3, v1
    v_lshlrev_b32 v9, 4, v9
    v_lshl_add_u32 v8, v8, 12, v9
    s_lshl_b32 s5, s72, 11
    s_add_u32 m0, s5, 57600
    s_add_u32 s7, s4, 64512
    buffer_load_dwordx4 v8, s[48:51], s4 offen sc1 lds
    buffer_load_dwordx4 v8, s[48:51], s7 offen offset:1024 sc1 lds
    v_bfe_u32 v9, v1, 2, 3
    v_lshlrev_b32 v9, 5, v9
    v_and_b32 v10, 3, v1
    v_lshl_add_u32 v10, v10, 9, v9
    s_lshl_b32 s6, s81, 11
    s_lshl_b32 s7, s76, 8
    s_add_u32 s6, s6, s7
    s_add_u32 s6, s6, 606208
    buffer_load_dwordx2 v[36:37], v10, s[48:51], s6 offen sc1
    buffer_load_dwordx2 v[38:39], v10, s[48:51], s6 offen offset:16 sc1
    s_waitcnt vmcnt(0)
    s_waitcnt lgkmcnt(0)
    s_barrier
    s_mov_b32 s88, 0
Lgate_36:
    buffer_load_dword v12, v24, s[48:51], 0 offen sc1
    s_add_u32 s88, s88, 1
    s_waitcnt vmcnt(0)
    v_cmp_eq_u32 vcc, -1, v12
    s_cmp_gt_u32 s88, 32768
    s_cbranch_scc1 Lgated_37
    s_cbranch_vccnz Lgate_36
Lgated_37:
    s_branch L_nogemm
Lskip_34:
    s_add_u32 m0, s87, 24832
    s_nop 0
    buffer_load_dwordx4 v2, s[48:51], s90 offen offset:0 sc1 lds
    buffer_load_dwordx4 v2, s[48:51], s91 offen offset:1024 sc1 lds
    buffer_load_dwordx4 v2, s[48:51], s92 offen offset:2048 sc1 lds
    buffer_load_dwordx4 v2, s[48:51], s93 offen offset:3072 sc1 lds
    v_add_u32 v2, 262144, v2
    s_add_u32 m0, s87, 41216
    s_nop 0
    buffer_load_dwordx4 v2, s[48:51], s90 offen offset:0 sc1 lds
    buffer_load_dwordx4 v2, s[48:51], s91 offen offset:1024 sc1 lds
    buffer_load_dwordx4 v2, s[48:51], s92 offen offset:2048 sc1 lds
    buffer_load_dwordx4 v2, s[48:51], s93 offen offset:3072 sc1 lds
    v_add_u32 v2, 262144, v2
    s_cmp_ge_u32 s72, 3
    s_cbranch_scc1 Lskip_38
    s_mul_i32 s4, s26, 6
    s_lshl_b32 s5, s72, 1
    s_add_u32 s4, s4, s5
    s_lshl_b32 s5, s72, 11
    s_add_u32 s6, s4, 0
    s_min_u32 s6, s6, 85
    s_lshl_b32 s6, s6, 10
    s_add_u32 s6, s6, 393216
    s_add_u32 m0, s5, 73984
    s_nop 0
    buffer_load_dwordx4 v3, s[48:51], s6 offen sc1 lds
    s_add_u32 s6, s4, 1
    s_min_u32 s6, s6, 85
    s_lshl_b32 s6, s6, 10
    s_add_u32 s6, s6, 393216
    s_add_u32 m0, s5, 75008
    s_nop 0
    buffer_load_dwordx4 v3, s[48:51], s6 offen sc1 lds
Lskip_38:
    s_mov_b32 s89, 0
    buffer_load_dwordx4 a[0:3], v244, s[48:51], s89 offen offset:0 sc1
    buffer_load_dwordx4 a[4:7], v243, s[48:51], s89 offen offset:0 sc1
    s_mov_b32 s89, 4096
    buffer_load_dwordx4 a[8:11], v244, s[48:51], s89 offen offset:2048 sc1
    buffer_load_dwordx4 a[12:15], v243, s[48:51], s89 offen offset:2048 sc1
    s_waitcnt vmcnt(8)
    s_waitcnt lgkmcnt(0)
    s_barrier
    ds_read_b64_tr_b16 v[52:53], v16 offset:0
    ds_read_b64_tr_b16 v[54:55], v16 offset:2048
    ds_read_b64_tr_b16 v[40:41], v13 offset:0
    ds_read_b64_tr_b16 v[42:43], v13 offset:1536
    ds_read_b64_tr_b16 v[56:57], v17 offset:0
    ds_read_b64_tr_b16 v[58:59], v17 offset:2048
    ds_read_b64_tr_b16 v[44:45], v13 offset:32
    ds_read_b64_tr_b16 v[46:47], v13 offset:1568
    ds_read_b64_tr_b16 v[48:49], v13 offset:64
    ds_read_b64_tr_b16 v[50:51], v13 offset:1600
    s_waitcnt lgkmcnt(6)
    v_mfma_f32_32x32x16_bf16 v[72:87], v[40:43], v[52:55], 0
    ds_read_b64_tr_b16 v[180:181], v16 offset:4096
    ds_read_b64_tr_b16 v[182:183], v16 offset:6144
    s_add_u32 m0, s24, 0
    s_waitcnt lgkmcnt(6)
    v_mfma_f32_32x32x16_bf16 v[88:103], v[40:43], v[56:59], 0
    ds_read_b64_tr_b16 v[168:169], v13 offset:6208
    ds_read_b64_tr_b16 v[170:171], v13 offset:7744
    buffer_load_dwordx4 v253, s[40:43], s23 offen offset:0 lds
    s_waitcnt lgkmcnt(6)
    v_mfma_f32_32x32x16_bf16 v[104:119], v[44:47], v[52:55], 0
    ds_read_b64_tr_b16 v[184:185], v17 offset:4096
    ds_read_b64_tr_b16 v[186:187], v17 offset:6144
    buffer_load_dwordx4 v252, s[40:43], s23 offen offset:1024 lds
    v_mfma_f32_32x32x16_bf16 v[120:135], v[44:47], v[56:59], 0
    ds_read_b64_tr_b16 v[172:173], v13 offset:6240
    ds_read_b64_tr_b16 v[174:175], v13 offset:7776
    buffer_load_dwordx4 v251, s[40:43], s23 offen offset:2048 lds
    s_waitcnt lgkmcnt(8)
    v_mfma_f32_32x32x16_bf16 v[136:151], v[48:51], v[52:55], 0
    ds_read_b64_tr_b16 v[176:177], v13 offset:6272
    ds_read_b64_tr_b16 v[178:179], v13 offset:7808
    s_add_u32 m0, s24, 3104
    v_mfma_f32_32x32x16_bf16 v[152:167], v[48:51], v[56:59], 0
    s_waitcnt lgkmcnt(6)
    v_mfma_f32_32x32x16_bf16 v[72:87], v[168:171], v[180:183], v[72:87]
    ds_read_b64_tr_b16 v[52:53], v16 offset:8192
    ds_read_b64_tr_b16 v[54:55], v16 offset:10240
    buffer_load_dwordx4 v253, s[44:47], s23 offen offset:0 lds
    s_waitcnt lgkmcnt(6)
    v_mfma_f32_32x32x16_bf16 v[88:103], v[168:171], v[184:187], v[88:103]
    ds_read_b64_tr_b16 v[40:41], v13 offset:12416
    ds_read_b64_tr_b16 v[42:43], v13 offset:13952
    buffer_load_dwordx4 v252, s[44:47], s23 offen offset:1024 lds
    s_waitcnt lgkmcnt(6)
    v_mfma_f32_32x32x16_bf16 v[104:119], v[172:175], v[180:183], v[104:119]
    ds_read_b64_tr_b16 v[56:57], v17 offset:8192
    ds_read_b64_tr_b16 v[58:59], v17 offset:10240
    buffer_load_dwordx4 v251, s[44:47], s23 offen offset:2048 lds
    v_mfma_f32_32x32x16_bf16 v[120:135], v[172:175], v[184:187], v[120:135]
    ds_read_b64_tr_b16 v[44:45], v13 offset:12448
    ds_read_b64_tr_b16 v[46:47], v13 offset:13984
    s_add_u32 s23, s23, 176128
    s_waitcnt lgkmcnt(8)
    v_mfma_f32_32x32x16_bf16 v[136:151], v[176:179], v[180:183], v[136:151]
    ds_read_b64_tr_b16 v[48:49], v13 offset:12480
    ds_read_b64_tr_b16 v[50:51], v13 offset:14016
    s_add_u32 m0, s87, 57600
    v_mfma_f32_32x32x16_bf16 v[152:167], v[176:179], v[184:187], v[152:167]
    s_waitcnt lgkmcnt(6)
    v_mfma_f32_32x32x16_bf16 v[72:87], v[40:43], v[52:55], v[72:87]
    ds_read_b64_tr_b16 v[180:181], v16 offset:12288
    ds_read_b64_tr_b16 v[182:183], v16 offset:14336
    buffer_load_dwordx4 v2, s[48:51], s90 offen offset:0 sc1 lds
    s_waitcnt lgkmcnt(6)
    v_mfma_f32_32x32x16_bf16 v[88:103], v[40:43], v[56:59], v[88:103]
    ds_read_b64_tr_b16 v[168:169], v13 offset:18624
    ds_read_b64_tr_b16 v[170:171], v13 offset:20160
    buffer_load_dwordx4 v2, s[48:51], s91 offen offset:1024 sc1 lds
    s_waitcnt lgkmcnt(6)
    v_mfma_f32_32x32x16_bf16 v[104:119], v[44:47], v[52:55], v[104:119]
    ds_read_b64_tr_b16 v[184:185], v17 offset:12288
    ds_read_b64_tr_b16 v[186:187], v17 offset:14336
    buffer_load_dwordx4 v2, s[48:51], s92 offen offset:2048 sc1 lds
    v_mfma_f32_32x32x16_bf16 v[120:135], v[44:47], v[56:59], v[120:135]
    ds_read_b64_tr_b16 v[172:173], v13 offset:18656
    ds_read_b64_tr_b16 v[174:175], v13 offset:20192
    buffer_load_dwordx4 v2, s[48:51], s93 offen offset:3072 sc1 lds
    s_waitcnt lgkmcnt(8)
    v_mfma_f32_32x32x16_bf16 v[136:151], v[48:51], v[52:55], v[136:151]
    ds_read_b64_tr_b16 v[176:177], v13 offset:18688
    ds_read_b64_tr_b16 v[178:179], v13 offset:20224
    v_add_u32 v2, 262144, v2
    v_mfma_f32_32x32x16_bf16 v[152:167], v[48:51], v[56:59], v[152:167]
    s_waitcnt lgkmcnt(0)
    s_waitcnt vmcnt(14)
    s_barrier
    v_mfma_f32_32x32x16_bf16 v[72:87], v[168:171], v[180:183], v[72:87]
    ds_read_b64_tr_b16 v[52:53], v18 offset:0
    ds_read_b64_tr_b16 v[54:55], v18 offset:2048
    s_add_u32 m0, s24, 108544
    v_mfma_f32_32x32x16_bf16 v[88:103], v[168:171], v[184:187], v[88:103]
    ds_read_b64_tr_b16 v[40:41], v14 offset:0
    ds_read_b64_tr_b16 v[42:43], v14 offset:1536
    buffer_load_dwordx4 v253, s[40:43], s23 offen offset:0 lds
    v_mfma_f32_32x32x16_bf16 v[104:119], v[172:175], v[180:183], v[104:119]
    ds_read_b64_tr_b16 v[56:57], v19 offset:0
    ds_read_b64_tr_b16 v[58:59], v19 offset:2048
    v_mfma_f32_32x32x16_bf16 v[120:135], v[172:175], v[184:187], v[120:135]
    ds_read_b64_tr_b16 v[44:45], v14 offset:32
    ds_read_b64_tr_b16 v[46:47], v14 offset:1568
    buffer_load_dwordx4 v252, s[40:43], s23 offen offset:1024 lds
    v_mfma_f32_32x32x16_bf16 v[136:151], v[176:179], v[180:183], v[136:151]
    ds_read_b64_tr_b16 v[48:49], v14 offset:64
    ds_read_b64_tr_b16 v[50:51], v14 offset:1600
    buffer_load_dwordx4 v251, s[40:43], s23 offen offset:2048 lds
    v_mfma_f32_32x32x16_bf16 v[152:167], v[176:179], v[184:187], v[152:167]
    s_waitcnt lgkmcnt(6)
    v_mfma_f32_32x32x16_bf16 v[72:87], v[40:43], v[52:55], v[72:87]
    ds_read_b64_tr_b16 v[180:181], v18 offset:4096
    ds_read_b64_tr_b16 v[182:183], v18 offset:6144
    s_add_u32 m0, s24, 111648
    s_waitcnt lgkmcnt(6)
    v_mfma_f32_32x32x16_bf16 v[88:103], v[40:43], v[56:59], v[88:103]
    ds_read_b64_tr_b16 v[168:169], v14 offset:6208
    ds_read_b64_tr_b16 v[170:171], v14 offset:7744
    buffer_load_dwordx4 v253, s[44:47], s23 offen offset:0 lds
    s_waitcnt lgkmcnt(6)
    v_mfma_f32_32x32x16_bf16 v[104:119], v[44:47], v[52:55], v[104:119]
    ds_read_b64_tr_b16 v[184:185], v19 offset:4096
    ds_read_b64_tr_b16 v[186:187], v19 offset:6144
    v_mfma_f32_32x32x16_bf16 v[120:135], v[44:47], v[56:59], v[120:135]
    ds_read_b64_tr_b16 v[172:173], v14 offset:6240
    ds_read_b64_tr_b16 v[174:175], v14 offset:7776
    buffer_load_dwordx4 v252, s[44:47], s23 offen offset:1024 lds
    s_waitcnt lgkmcnt(8)
    v_mfma_f32_32x32x16_bf16 v[136:151], v[48:51], v[52:55], v[136:151]
    ds_read_b64_tr_b16 v[176:177], v14 offset:6272
    ds_read_b64_tr_b16 v[178:179], v14 offset:7808
    buffer_load_dwordx4 v251, s[44:47], s23 offen offset:2048 lds
    v_mfma_f32_32x32x16_bf16 v[152:167], v[48:51], v[56:59], v[152:167]
    s_waitcnt lgkmcnt(6)
    v_mfma_f32_32x32x16_bf16 v[72:87], v[168:171], v[180:183], v[72:87]
    ds_read_b64_tr_b16 v[52:53], v18 offset:8192
    ds_read_b64_tr_b16 v[54:55], v18 offset:10240
    s_add_u32 s23, s23, 176128
    s_waitcnt lgkmcnt(6)
    v_mfma_f32_32x32x16_bf16 v[88:103], v[168:171], v[184:187], v[88:103]
    ds_read_b64_tr_b16 v[40:41], v14 offset:12416
    ds_read_b64_tr_b16 v[42:43], v14 offset:13952
    s_add_u32 m0, s87, 24832
    s_waitcnt lgkmcnt(6)
    v_mfma_f32_32x32x16_bf16 v[104:119], v[172:175], v[180:183], v[104:119]
    ds_read_b64_tr_b16 v[56:57], v19 offset:8192
    ds_read_b64_tr_b16 v[58:59], v19 offset:10240
    v_mfma_f32_32x32x16_bf16 v[120:135], v[172:175], v[184:187], v[120:135]
    ds_read_b64_tr_b16 v[44:45], v14 offset:12448
    ds_read_b64_tr_b16 v[46:47], v14 offset:13984
    buffer_load_dwordx4 v2, s[48:51], s90 offen offset:0 sc1 lds
    s_waitcnt lgkmcnt(8)
    v_mfma_f32_32x32x16_bf16 v[136:151], v[176:179], v[180:183], v[136:151]
    ds_read_b64_tr_b16 v[48:49], v14 offset:12480
    ds_read_b64_tr_b16 v[50:51], v14 offset:14016
    buffer_load_dwordx4 v2, s[48:51], s91 offen offset:1024 sc1 lds
    v_mfma_f32_32x32x16_bf16 v[152:167], v[176:179], v[184:187], v[152:167]
    s_waitcnt lgkmcnt(6)
    v_mfma_f32_32x32x16_bf16 v[72:87], v[40:43], v[52:55], v[72:87]
    ds_read_b64_tr_b16 v[180:181], v18 offset:12288
    ds_read_b64_tr_b16 v[182:183], v18 offset:14336
    buffer_load_dwordx4 v2, s[48:51], s92 offen offset:2048 sc1 lds
    s_waitcnt lgkmcnt(6)
    v_mfma_f32_32x32x16_bf16 v[88:103], v[40:43], v[56:59], v[88:103]
    ds_read_b64_tr_b16 v[168:169], v14 offset:18624
    ds_read_b64_tr_b16 v[170:171], v14 offset:20160
    s_waitcnt lgkmcnt(6)
    v_mfma_f32_32x32x16_bf16 v[104:119], v[44:47], v[52:55], v[104:119]
    ds_read_b64_tr_b16 v[184:185], v19 offset:12288
    ds_read_b64_tr_b16 v[186:187], v19 offset:14336
    buffer_load_dwordx4 v2, s[48:51], s93 offen offset:3072 sc1 lds
    v_mfma_f32_32x32x16_bf16 v[120:135], v[44:47], v[56:59], v[120:135]
    ds_read_b64_tr_b16 v[172:173], v14 offset:18656
    ds_read_b64_tr_b16 v[174:175], v14 offset:20192
    s_waitcnt lgkmcnt(8)
    v_mfma_f32_32x32x16_bf16 v[136:151], v[48:51], v[52:55], v[136:151]
    ds_read_b64_tr_b16 v[176:177], v14 offset:18688
    ds_read_b64_tr_b16 v[178:179], v14 offset:20224
    v_add_u32 v2, 262144, v2
    v_mfma_f32_32x32x16_bf16 v[152:167], v[48:51], v[56:59], v[152:167]
    s_waitcnt lgkmcnt(0)
    s_waitcnt vmcnt(10)
    s_barrier
    v_mfma_f32_32x32x16_bf16 v[72:87], v[168:171], v[180:183], v[72:87]
    ds_read_b64_tr_b16 v[52:53], v20 offset:0
    ds_read_b64_tr_b16 v[54:55], v20 offset:2048
    s_add_u32 m0, s24, 133376
    v_mfma_f32_32x32x16_bf16 v[88:103], v[168:171], v[184:187], v[88:103]
    ds_read_b64_tr_b16 v[40:41], v15 offset:0
    ds_read_b64_tr_b16 v[42:43], v15 offset:1536
    buffer_load_dwordx4 v253, s[40:43], s23 offen offset:0 lds
    v_mfma_f32_32x32x16_bf16 v[104:119], v[172:175], v[180:183], v[104:119]
    ds_read_b64_tr_b16 v[56:57], v21 offset:0
    ds_read_b64_tr_b16 v[58:59], v21 offset:2048
    v_mfma_f32_32x32x16_bf16 v[120:135], v[172:175], v[184:187], v[120:135]
    ds_read_b64_tr_b16 v[44:45], v15 offset:32
    ds_read_b64_tr_b16 v[46:47], v15 offset:1568
    buffer_load_dwordx4 v252, s[40:43], s23 offen offset:1024 lds
    v_mfma_f32_32x32x16_bf16 v[136:151], v[176:179], v[180:183], v[136:151]
    ds_read_b64_tr_b16 v[48:49], v15 offset:64
    ds_read_b64_tr_b16 v[50:51], v15 offset:1600
    buffer_load_dwordx4 v251, s[40:43], s23 offen offset:2048 lds
    v_mfma_f32_32x32x16_bf16 v[152:167], v[176:179], v[184:187], v[152:167]
    s_waitcnt lgkmcnt(6)
    v_mfma_f32_32x32x16_bf16 v[72:87], v[40:43], v[52:55], v[72:87]
    ds_read_b64_tr_b16 v[180:181], v20 offset:4096
    ds_read_b64_tr_b16 v[182:183], v20 offset:6144
    s_add_u32 m0, s24, 136480
    s_waitcnt lgkmcnt(6)
    v_mfma_f32_32x32x16_bf16 v[88:103], v[40:43], v[56:59], v[88:103]
    ds_read_b64_tr_b16 v[168:169], v15 offset:6208
    ds_read_b64_tr_b16 v[170:171], v15 offset:7744
    buffer_load_dwordx4 v253, s[44:47], s23 offen offset:0 lds
    s_waitcnt lgkmcnt(6)
    v_mfma_f32_32x32x16_bf16 v[104:119], v[44:47], v[52:55], v[104:119]
    ds_read_b64_tr_b16 v[184:185], v21 offset:4096
    ds_read_b64_tr_b16 v[186:187], v21 offset:6144
    v_mfma_f32_32x32x16_bf16 v[120:135], v[44:47], v[56:59], v[120:135]
    ds_read_b64_tr_b16 v[172:173], v15 offset:6240
    ds_read_b64_tr_b16 v[174:175], v15 offset:7776
    buffer_load_dwordx4 v252, s[44:47], s23 offen offset:1024 lds
    s_waitcnt lgkmcnt(8)
    v_mfma_f32_32x32x16_bf16 v[136:151], v[48:51], v[52:55], v[136:151]
    ds_read_b64_tr_b16 v[176:177], v15 offset:6272
    ds_read_b64_tr_b16 v[178:179], v15 offset:7808
    buffer_load_dwordx4 v251, s[44:47], s23 offen offset:2048 lds
    v_mfma_f32_32x32x16_bf16 v[152:167], v[48:51], v[56:59], v[152:167]
    s_waitcnt lgkmcnt(6)
    v_mfma_f32_32x32x16_bf16 v[72:87], v[168:171], v[180:183], v[72:87]
    ds_read_b64_tr_b16 v[52:53], v20 offset:8192
    ds_read_b64_tr_b16 v[54:55], v20 offset:10240
    s_add_u32 s23, s23, 176128
    s_waitcnt lgkmcnt(6)
    v_mfma_f32_32x32x16_bf16 v[88:103], v[168:171], v[184:187], v[88:103]
    ds_read_b64_tr_b16 v[40:41], v15 offset:12416
    ds_read_b64_tr_b16 v[42:43], v15 offset:13952
    s_add_u32 m0, s87, 41216
    s_waitcnt lgkmcnt(6)
    v_mfma_f32_32x32x16_bf16 v[104:119], v[172:175], v[180:183], v[104:119]
    ds_read_b64_tr_b16 v[56:57], v21 offset:8192
    ds_read_b64_tr_b16 v[58:59], v21 offset:10240
    v_mfma_f32_32x32x16_bf16 v[120:135], v[172:175], v[184:187], v[120:135]
    ds_read_b64_tr_b16 v[44:45], v15 offset:12448
    ds_read_b64_tr_b16 v[46:47], v15 offset:13984
    buffer_load_dwordx4 v2, s[48:51], s90 offen offset:0 sc1 lds
    s_waitcnt lgkmcnt(8)
    v_mfma_f32_32x32x16_bf16 v[136:151], v[176:179], v[180:183], v[136:151]
    ds_read_b64_tr_b16 v[48:49], v15 offset:12480
    ds_read_b64_tr_b16 v[50:51], v15 offset:14016
    buffer_load_dwordx4 v2, s[48:51], s91 offen offset:1024 sc1 lds
    v_mfma_f32_32x32x16_bf16 v[152:167], v[176:179], v[184:187], v[152:167]
    s_waitcnt lgkmcnt(6)
    v_mfma_f32_32x32x16_bf16 v[72:87], v[40:43], v[52:55], v[72:87]
    ds_read_b64_tr_b16 v[180:181], v20 offset:12288
    ds_read_b64_tr_b16 v[182:183], v20 offset:14336
    buffer_load_dwordx4 v2, s[48:51], s92 offen offset:2048 sc1 lds
    s_waitcnt lgkmcnt(6)
    v_mfma_f32_32x32x16_bf16 v[88:103], v[40:43], v[56:59], v[88:103]
    ds_read_b64_tr_b16 v[168:169], v15 offset:18624
    ds_read_b64_tr_b16 v[170:171], v15 offset:20160
    s_waitcnt lgkmcnt(6)
    v_mfma_f32_32x32x16_bf16 v[104:119], v[44:47], v[52:55], v[104:119]
    ds_read_b64_tr_b16 v[184:185], v21 offset:12288
    ds_read_b64_tr_b16 v[186:187], v21 offset:14336
    buffer_load_dwordx4 v2, s[48:51], s93 offen offset:3072 sc1 lds
    v_mfma_f32_32x32x16_bf16 v[120:135], v[44:47], v[56:59], v[120:135]
    ds_read_b64_tr_b16 v[172:173], v15 offset:18656
    ds_read_b64_tr_b16 v[174:175], v15 offset:20192
    s_waitcnt lgkmcnt(8)
    v_mfma_f32_32x32x16_bf16 v[136:151], v[48:51], v[52:55], v[136:151]
    ds_read_b64_tr_b16 v[176:177], v15 offset:18688
    ds_read_b64_tr_b16 v[178:179], v15 offset:20224
    v_add_u32 v2, 262144, v2
    v_mfma_f32_32x32x16_bf16 v[152:167], v[48:51], v[56:59], v[152:167]
    s_waitcnt lgkmcnt(0)
    s_waitcnt vmcnt(10)
    s_barrier
    v_mfma_f32_32x32x16_bf16 v[72:87], v[168:171], v[180:183], v[72:87]
    ds_read_b64_tr_b16 v[52:53], v16 offset:0
    ds_read_b64_tr_b16 v[54:55], v16 offset:2048
    s_add_u32 m0, s24, 0
    v_mfma_f32_32x32x16_bf16 v[88:103], v[168:171], v[184:187], v[88:103]
    ds_read_b64_tr_b16 v[40:41], v13 offset:0
    ds_read_b64_tr_b16 v[42:43], v13 offset:1536
    buffer_load_dwordx4 v253, s[40:43], s23 offen offset:0 lds
    v_mfma_f32_32x32x16_bf16 v[104:119], v[172:175], v[180:183], v[104:119]
    ds_read_b64_tr_b16 v[56:57], v17 offset:0
    ds_read_b64_tr_b16 v[58:59], v17 offset:2048
    v_mfma_f32_32x32x16_bf16 v[120:135], v[172:175], v[184:187], v[120:135]
    ds_read_b64_tr_b16 v[44:45], v13 offset:32
    ds_read_b64_tr_b16 v[46:47], v13 offset:1568
    buffer_load_dwordx4 v252, s[40:43], s23 offen offset:1024 lds
    v_mfma_f32_32x32x16_bf16 v[136:151], v[176:179], v[180:183], v[136:151]
    ds_read_b64_tr_b16 v[48:49], v13 offset:64
    ds_read_b64_tr_b16 v[50:51], v13 offset:1600
    buffer_load_dwordx4 v251, s[40:43], s23 offen offset:2048 lds
    v_mfma_f32_32x32x16_bf16 v[152:167], v[176:179], v[184:187], v[152:167]
    s_waitcnt lgkmcnt(6)
    v_mfma_f32_32x32x16_bf16 v[72:87], v[40:43], v[52:55], v[72:87]
    ds_read_b64_tr_b16 v[180:181], v16 offset:4096
    ds_read_b64_tr_b16 v[182:183], v16 offset:6144
    s_add_u32 m0, s24, 3104
    s_waitcnt lgkmcnt(6)
    v_mfma_f32_32x32x16_bf16 v[88:103], v[40:43], v[56:59], v[88:103]
    ds_read_b64_tr_b16 v[168:169], v13 offset:6208
    ds_read_b64_tr_b16 v[170:171], v13 offset:7744
    buffer_load_dwordx4 v253, s[44:47], s23 offen offset:0 lds
    s_waitcnt lgkmcnt(6)
    v_mfma_f32_32x32x16_bf16 v[104:119], v[44:47], v[52:55], v[104:119]
    ds_read_b64_tr_b16 v[184:185], v17 offset:4096
    ds_read_b64_tr_b16 v[186:187], v17 offset:6144
    v_mfma_f32_32x32x16_bf16 v[120:135], v[44:47], v[56:59], v[120:135]
    ds_read_b64_tr_b16 v[172:173], v13 offset:6240
    ds_read_b64_tr_b16 v[174:175], v13 offset:7776
    buffer_load_dwordx4 v252, s[44:47], s23 offen offset:1024 lds
    s_waitcnt lgkmcnt(8)
    v_mfma_f32_32x32x16_bf16 v[136:151], v[48:51], v[52:55], v[136:151]
    ds_read_b64_tr_b16 v[176:177], v13 offset:6272
    ds_read_b64_tr_b16 v[178:179], v13 offset:7808
    buffer_load_dwordx4 v251, s[44:47], s23 offen offset:2048 lds
    v_mfma_f32_32x32x16_bf16 v[152:167], v[48:51], v[56:59], v[152:167]
    s_mov_b32 s89, 12288
    s_waitcnt lgkmcnt(6)
    v_mfma_f32_32x32x16_bf16 v[72:87], v[168:171], v[180:183], v[72:87]
    ds_read_b64_tr_b16 v[52:53], v16 offset:8192
    ds_read_b64_tr_b16 v[54:55], v16 offset:10240
    s_add_u32 s23, s23, 176128
    s_waitcnt lgkmcnt(6)
    v_mfma_f32_32x32x16_bf16 v[88:103], v[168:171], v[184:187], v[88:103]
    ds_read_b64_tr_b16 v[40:41], v13 offset:12416
    ds_read_b64_tr_b16 v[42:43], v13 offset:13952
    s_add_u32 m0, s87, 57600
    s_waitcnt lgkmcnt(6)
    v_mfma_f32_32x32x16_bf16 v[104:119], v[172:175], v[180:183], v[104:119]
    buffer_load_dwordx4 a[16:19], v244, s[48:51], s89 offen offset:0 sc1
    ds_read_b64_tr_b16 v[56:57], v17 offset:8192
    ds_read_b64_tr_b16 v[58:59], v17 offset:10240
    v_mfma_f32_32x32x16_bf16 v[120:135], v[172:175], v[184:187], v[120:135]
    ds_read_b64_tr_b16 v[44:45], v13 offset:12448
    ds_read_b64_tr_b16 v[46:47], v13 offset:13984
    buffer_load_dwordx4 v2, s[48:51], s90 offen offset:0 sc1 lds
    s_waitcnt lgkmcnt(8)
    v_mfma_f32_32x32x16_bf16 v[136:151], v[176:179], v[180:183], v[136:151]
    ds_read_b64_tr_b16 v[48:49], v13 offset:12480
    ds_read_b64_tr_b16 v[50:51], v13 offset:14016
    buffer_load_dwordx4 v2, s[48:51], s91 offen offset:1024 sc1 lds
    v_mfma_f32_32x32x16_bf16 v[152:167], v[176:179], v[184:187], v[152:167]
    buffer_load_dwordx4 a[20:23], v243, s[48:51], s89 offen offset:0 sc1
    s_waitcnt lgkmcnt(6)
    v_mfma_f32_32x32x16_bf16 v[72:87], v[40:43], v[52:55], v[72:87]
    ds_read_b64_tr_b16 v[180:181], v16 offset:12288
    ds_read_b64_tr_b16 v[182:183], v16 offset:14336
    buffer_load_dwordx4 v2, s[48:51], s92 offen offset:2048 sc1 lds
    s_waitcnt lgkmcnt(6)
    v_mfma_f32_32x32x16_bf16 v[88:103], v[40:43], v[56:59], v[88:103]
    ds_read_b64_tr_b16 v[168:169], v13 offset:18624
    ds_read_b64_tr_b16 v[170:171], v13 offset:20160
    s_waitcnt lgkmcnt(6)
    v_mfma_f32_32x32x16_bf16 v[104:119], v[44:47], v[52:55], v[104:119]
    ds_read_b64_tr_b16 v[184:185], v17 offset:12288
    ds_read_b64_tr_b16 v[186:187], v17 offset:14336
    buffer_load_dwordx4 v2, s[48:51], s93 offen offset:3072 sc1 lds
    v_mfma_f32_32x32x16_bf16 v[120:135], v[44:47], v[56:59], v[120:135]
    ds_read_b64_tr_b16 v[172:173], v13 offset:18656
    ds_read_b64_tr_b16 v[174:175], v13 offset:20192
    s_waitcnt lgkmcnt(8)
    v_mfma_f32_32x32x16_bf16 v[136:151], v[48:51], v[52:55], v[136:151]
    ds_read_b64_tr_b16 v[176:177], v13 offset:18688
    ds_read_b64_tr_b16 v[178:179], v13 offset:20224
    v_add_u32 v2, 262144, v2
    v_mfma_f32_32x32x16_bf16 v[152:167], v[48:51], v[56:59], v[152:167]
    s_mov_b32 s89, 16384
    s_waitcnt lgkmcnt(0)
    s_waitcnt vmcnt(12)
    s_barrier
    v_mfma_f32_32x32x16_bf16 v[72:87], v[168:171], v[180:183], v[72:87]
    ds_read_b64_tr_b16 v[52:53], v18 offset:0
    ds_read_b64_tr_b16 v[54:55], v18 offset:2048
    s_add_u32 m0, s24, 108544
    v_mfma_f32_32x32x16_bf16 v[88:103], v[168:171], v[184:187], v[88:103]
    ds_read_b64_tr_b16 v[40:41], v14 offset:0
    ds_read_b64_tr_b16 v[42:43], v14 offset:1536
    buffer_load_dwordx4 v253, s[40:43], s23 offen offset:0 lds
    v_mfma_f32_32x32x16_bf16 v[104:119], v[172:175], v[180:183], v[104:119]
    buffer_load_dwordx4 a[24:27], v244, s[48:51], s89 offen offset:2048 sc1
    ds_read_b64_tr_b16 v[56:57], v19 offset:0
    ds_read_b64_tr_b16 v[58:59], v19 offset:2048
    v_mfma_f32_32x32x16_bf16 v[120:135], v[172:175], v[184:187], v[120:135]
    ds_read_b64_tr_b16 v[44:45], v14 offset:32
    ds_read_b64_tr_b16 v[46:47], v14 offset:1568
    buffer_load_dwordx4 v252, s[40:43], s23 offen offset:1024 lds
    v_mfma_f32_32x32x16_bf16 v[136:151], v[176:179], v[180:183], v[136:151]
    ds_read_b64_tr_b16 v[48:49], v14 offset:64
    ds_read_b64_tr_b16 v[50:51], v14 offset:1600
    buffer_load_dwordx4 v251, s[40:43], s23 offen offset:2048 lds
    v_mfma_f32_32x32x16_bf16 v[152:167], v[176:179], v[184:187], v[152:167]
    buffer_load_dwordx4 a[28:31], v243, s[48:51], s89 offen offset:2048 sc1
    s_waitcnt lgkmcnt(6)
    v_mfma_f32_32x32x16_bf16 v[72:87], v[40:43], v[52:55], v[72:87]
    ds_read_b64_tr_b16 v[180:181], v18 offset:4096
    ds_read_b64_tr_b16 v[182:183], v18 offset:6144
    s_add_u32 m0, s24, 111648
    s_waitcnt lgkmcnt(6)
    v_mfma_f32_32x32x16_bf16 v[88:103], v[40:43], v[56:59], v[88:103]
    ds_read_b64_tr_b16 v[168:169], v14 offset:6208
    ds_read_b64_tr_b16 v[170:171], v14 offset:7744
    buffer_load_dwordx4 v253, s[44:47], s23 offen offset:0 lds
    s_waitcnt lgkmcnt(6)
    v_mfma_f32_32x32x16_bf16 v[104:119], v[44:47], v[52:55], v[104:119]
    ds_read_b64_tr_b16 v[184:185], v19 offset:4096
    ds_read_b64_tr_b16 v[186:187], v19 offset:6144
    v_mfma_f32_32x32x16_bf16 v[120:135], v[44:47], v[56:59], v[120:135]
    ds_read_b64_tr_b16 v[172:173], v14 offset:6240
    ds_read_b64_tr_b16 v[174:175], v14 offset:7776
    buffer_load_dwordx4 v252, s[44:47], s23 offen offset:1024 lds
    s_waitcnt lgkmcnt(8)
    v_mfma_f32_32x32x16_bf16 v[136:151], v[48:51], v[52:55], v[136:151]
    ds_read_b64_tr_b16 v[176:177], v14 offset:6272
    ds_read_b64_tr_b16 v[178:179], v14 offset:7808
    buffer_load_dwordx4 v251, s[44:47], s23 offen offset:2048 lds
    v_mfma_f32_32x32x16_bf16 v[152:167], v[48:51], v[56:59], v[152:167]
    s_mov_b32 s89, 24576
    s_waitcnt lgkmcnt(6)
    v_mfma_f32_32x32x16_bf16 v[72:87], v[168:171], v[180:183], v[72:87]
    ds_read_b64_tr_b16 v[52:53], v18 offset:8192
    ds_read_b64_tr_b16 v[54:55], v18 offset:10240
    s_add_u32 s23, s23, 176128
    s_waitcnt lgkmcnt(6)
    v_mfma_f32_32x32x16_bf16 v[88:103], v[168:171], v[184:187], v[88:103]
    ds_read_b64_tr_b16 v[40:41], v14 offset:12416
    ds_read_b64_tr_b16 v[42:43], v14 offset:13952
    s_add_u32 m0, s87, 24832
    s_waitcnt lgkmcnt(6)
    v_mfma_f32_32x32x16_bf16 v[104:119], v[172:175], v[180:183], v[104:119]
    buffer_load_dwordx4 a[32:35], v244, s[48:51], s89 offen offset:0 sc1
    ds_read_b64_tr_b16 v[56:57], v19 offset:8192
    ds_read_b64_tr_b16 v[58:59], v19 offset:10240
    v_mfma_f32_32x32x16_bf16 v[120:135], v[172:175], v[184:187], v[120:135]
    ds_read_b64_tr_b16 v[44:45], v14 offset:12448
    ds_read_b64_tr_b16 v[46:47], v14 offset:13984
    buffer_load_dwordx4 v2, s[48:51], s90 offen offset:0 sc1 lds
    s_waitcnt lgkmcnt(8)
    v_mfma_f32_32x32x16_bf16 v[136:151], v[176:179], v[180:183], v[136:151]
    ds_read_b64_tr_b16 v[48:49], v14 offset:12480
    ds_read_b64_tr_b16 v[50:51], v14 offset:14016
    buffer_load_dwordx4 v2, s[48:51], s91 offen offset:1024 sc1 lds
    v_mfma_f32_32x32x16_bf16 v[152:167], v[176:179], v[184:187], v[152:167]
    buffer_load_dwordx4 a[36:39], v243, s[48:51], s89 offen offset:0 sc1
    s_waitcnt lgkmcnt(6)
    v_mfma_f32_32x32x16_bf16 v[72:87], v[40:43], v[52:55], v[72:87]
    ds_read_b64_tr_b16 v[180:181], v18 offset:12288
    ds_read_b64_tr_b16 v[182:183], v18 offset:14336
    buffer_load_dwordx4 v2, s[48:51], s92 offen offset:2048 sc1 lds
    s_waitcnt lgkmcnt(6)
    v_mfma_f32_32x32x16_bf16 v[88:103], v[40:43], v[56:59], v[88:103]
    ds_read_b64_tr_b16 v[168:169], v14 offset:18624
    ds_read_b64_tr_b16 v[170:171], v14 offset:20160
    s_waitcnt lgkmcnt(6)
    v_mfma_f32_32x32x16_bf16 v[104:119], v[44:47], v[52:55], v[104:119]
    ds_read_b64_tr_b16 v[184:185], v19 offset:12288
    ds_read_b64_tr_b16 v[186:187], v19 offset:14336
    buffer_load_dwordx4 v2, s[48:51], s93 offen offset:3072 sc1 lds
    v_mfma_f32_32x32x16_bf16 v[120:135], v[44:47], v[56:59], v[120:135]
    ds_read_b64_tr_b16 v[172:173], v14 offset:18656
    ds_read_b64_tr_b16 v[174:175], v14 offset:20192
    s_waitcnt lgkmcnt(8)
    v_mfma_f32_32x32x16_bf16 v[136:151], v[48:51], v[52:55], v[136:151]
    ds_read_b64_tr_b16 v[176:177], v14 offset:18688
    ds_read_b64_tr_b16 v[178:179], v14 offset:20224
    v_add_u32 v2, 262144, v2
    v_mfma_f32_32x32x16_bf16 v[152:167], v[48:51], v[56:59], v[152:167]
    s_mov_b32 s89, 28672
    s_waitcnt lgkmcnt(0)
    s_waitcnt vmcnt(14)
    s_barrier
    v_mfma_f32_32x32x16_bf16 v[72:87], v[168:171], v[180:183], v[72:87]
    ds_read_b64_tr_b16 v[52:53], v20 offset:0
    ds_read_b64_tr_b16 v[54:55], v20 offset:2048
    s_add_u32 m0, s24, 133376
    v_mfma_f32_32x32x16_bf16 v[88:103], v[168:171], v[184:187], v[88:103]
    ds_read_b64_tr_b16 v[40:41], v15 offset:0
    ds_read_b64_tr_b16 v[42:43], v15 offset:1536
    buffer_load_dwordx4 v253, s[40:43], s23 offen offset:0 lds
    v_mfma_f32_32x32x16_bf16 v[104:119], v[172:175], v[180:183], v[104:119]
    buffer_load_dwordx4 a[40:43], v244, s[48:51], s89 offen offset:2048 sc1
    ds_read_b64_tr_b16 v[56:57], v21 offset:0
    ds_read_b64_tr_b16 v[58:59], v21 offset:2048
    v_mfma_f32_32x32x16_bf16 v[120:135], v[172:175], v[184:187], v[120:135]
    ds_read_b64_tr_b16 v[44:45], v15 offset:32
    ds_read_b64_tr_b16 v[46:47], v15 offset:1568
    buffer_load_dwordx4 v252, s[40:43], s23 offen offset:1024 lds
    v_mfma_f32_32x32x16_bf16 v[136:151], v[176:179], v[180:183], v[136:151]
    ds_read_b64_tr_b16 v[48:49], v15 offset:64
    ds_read_b64_tr_b16 v[50:51], v15 offset:1600
    buffer_load_dwordx4 v251, s[40:43], s23 offen offset:2048 lds
    v_mfma_f32_32x32x16_bf16 v[152:167], v[176:179], v[184:187], v[152:167]
    buffer_load_dwordx4 a[44:47], v243, s[48:51], s89 offen offset:2048 sc1
    s_waitcnt lgkmcnt(6)
    v_mfma_f32_32x32x16_bf16 v[72:87], v[40:43], v[52:55], v[72:87]
    ds_read_b64_tr_b16 v[180:181], v20 offset:4096
    ds_read_b64_tr_b16 v[182:183], v20 offset:6144
    s_add_u32 m0, s24, 136480
    s_waitcnt lgkmcnt(6)
    v_mfma_f32_32x32x16_bf16 v[88:103], v[40:43], v[56:59], v[88:103]
    ds_read_b64_tr_b16 v[168:169], v15 offset:6208
    ds_read_b64_tr_b16 v[170:171], v15 offset:7744
    buffer_load_dwordx4 v253, s[44:47], s23 offen offset:0 lds
    s_waitcnt lgkmcnt(6)
    v_mfma_f32_32x32x16_bf16 v[104:119], v[44:47], v[52:55], v[104:119]
    ds_read_b64_tr_b16 v[184:185], v21 offset:4096
    ds_read_b64_tr_b16 v[186:187], v21 offset:6144
    v_mfma_f32_32x32x16_bf16 v[120:135], v[44:47], v[56:59], v[120:135]
    ds_read_b64_tr_b16 v[172:173], v15 offset:6240
    ds_read_b64_tr_b16 v[174:175], v15 offset:7776
    buffer_load_dwordx4 v252, s[44:47], s23 offen offset:1024 lds
    s_waitcnt lgkmcnt(8)
    v_mfma_f32_32x32x16_bf16 v[136:151], v[48:51], v[52:55], v[136:151]
    ds_read_b64_tr_b16 v[176:177], v15 offset:6272
    ds_read_b64_tr_b16 v[178:179], v15 offset:7808
    buffer_load_dwordx4 v251, s[44:47], s23 offen offset:2048 lds
    v_mfma_f32_32x32x16_bf16 v[152:167], v[48:51], v[56:59], v[152:167]
    s_mov_b32 s89, 36864
    s_waitcnt lgkmcnt(6)
    v_mfma_f32_32x32x16_bf16 v[72:87], v[168:171], v[180:183], v[72:87]
    ds_read_b64_tr_b16 v[52:53], v20 offset:8192
    ds_read_b64_tr_b16 v[54:55], v20 offset:10240
    s_add_u32 s23, s23, 176128
    s_waitcnt lgkmcnt(6)
    v_mfma_f32_32x32x16_bf16 v[88:103], v[168:171], v[184:187], v[88:103]
    ds_read_b64_tr_b16 v[40:41], v15 offset:12416
    ds_read_b64_tr_b16 v[42:43], v15 offset:13952
    s_add_u32 m0, s87, 41216
    s_waitcnt lgkmcnt(6)
    v_mfma_f32_32x32x16_bf16 v[104:119], v[172:175], v[180:183], v[104:119]
    buffer_load_dwordx4 a[48:51], v244, s[48:51], s89 offen offset:0 sc1
    ds_read_b64_tr_b16 v[56:57], v21 offset:8192
    ds_read_b64_tr_b16 v[58:59], v21 offset:10240
    v_mfma_f32_32x32x16_bf16 v[120:135], v[172:175], v[184:187], v[120:135]
    ds_read_b64_tr_b16 v[44:45], v15 offset:12448
    ds_read_b64_tr_b16 v[46:47], v15 offset:13984
    buffer_load_dwordx4 v2, s[48:51], s90 offen offset:0 sc1 lds
    s_waitcnt lgkmcnt(8)
    v_mfma_f32_32x32x16_bf16 v[136:151], v[176:179], v[180:183], v[136:151]
    ds_read_b64_tr_b16 v[48:49], v15 offset:12480
    ds_read_b64_tr_b16 v[50:51], v15 offset:14016
    buffer_load_dwordx4 v2, s[48:51], s91 offen offset:1024 sc1 lds
    v_mfma_f32_32x32x16_bf16 v[152:167], v[176:179], v[184:187], v[152:167]
    buffer_load_dwordx4 a[52:55], v243, s[48:51], s89 offen offset:0 sc1
    s_waitcnt lgkmcnt(6)
    v_mfma_f32_32x32x16_bf16 v[72:87], v[40:43], v[52:55], v[72:87]
    ds_read_b64_tr_b16 v[180:181], v20 offset:12288
    ds_read_b64_tr_b16 v[182:183], v20 offset:14336
    buffer_load_dwordx4 v2, s[48:51], s92 offen offset:2048 sc1 lds
    s_waitcnt lgkmcnt(6)
    v_mfma_f32_32x32x16_bf16 v[88:103], v[40:43], v[56:59], v[88:103]
    ds_read_b64_tr_b16 v[168:169], v15 offset:18624
    ds_read_b64_tr_b16 v[170:171], v15 offset:20160
    s_waitcnt lgkmcnt(6)
    v_mfma_f32_32x32x16_bf16 v[104:119], v[44:47], v[52:55], v[104:119]
    ds_read_b64_tr_b16 v[184:185], v21 offset:12288
    ds_read_b64_tr_b16 v[186:187], v21 offset:14336
    buffer_load_dwordx4 v2, s[48:51], s93 offen offset:3072 sc1 lds
    v_mfma_f32_32x32x16_bf16 v[120:135], v[44:47], v[56:59], v[120:135]
    ds_read_b64_tr_b16 v[172:173], v15 offset:18656
    ds_read_b64_tr_b16 v[174:175], v15 offset:20192
    s_waitcnt lgkmcnt(8)
    v_mfma_f32_32x32x16_bf16 v[136:151], v[48:51], v[52:55], v[136:151]
    ds_read_b64_tr_b16 v[176:177], v15 offset:18688
    ds_read_b64_tr_b16 v[178:179], v15 offset:20224
    v_add_u32 v2, 262144, v2
    v_mfma_f32_32x32x16_bf16 v[152:167], v[48:51], v[56:59], v[152:167]
    s_mov_b32 s89, 0
    s_lshl_b32 s4, s25, 10
    s_lshl_b32 s5, s76, 9
    s_add_u32 s4, s4, s5
    s_add_u32 s4, s4, 360448
    v_and_b32 v12, 31, v1
    v_lshl_add_u32 v12, v12, 3, s4
    buffer_load_dwordx2 v[60:61], v12, s[48:51], 0 offen offset:0 sc1
    buffer_load_dwordx2 v[62:63], v12, s[48:51], 0 offen offset:256 sc1
    s_waitcnt lgkmcnt(0)
    s_waitcnt vmcnt(16)
    s_barrier
    v_mfma_f32_32x32x16_bf16 v[72:87], v[168:171], v[180:183], v[72:87]
    ds_read_b64_tr_b16 v[52:53], v16 offset:0
    ds_read_b64_tr_b16 v[54:55], v16 offset:2048
    v_mfma_f32_32x32x16_bf16 v[88:103], v[168:171], v[184:187], v[88:103]
    ds_read_b64_tr_b16 v[40:41], v13 offset:0
    ds_read_b64_tr_b16 v[42:43], v13 offset:1536
    v_mfma_f32_32x32x16_bf16 v[104:119], v[172:175], v[180:183], v[104:119]
    buffer_load_dwordx4 a[56:59], v244, s[48:51], s89 offen offset:2048 sc1
    ds_read_b64_tr_b16 v[56:57], v17 offset:0
    ds_read_b64_tr_b16 v[58:59], v17 offset:2048
    v_mfma_f32_32x32x16_bf16 v[120:135], v[172:175], v[184:187], v[120:135]
    ds_read_b64_tr_b16 v[44:45], v13 offset:32
    ds_read_b64_tr_b16 v[46:47], v13 offset:1568
    v_mfma_f32_32x32x16_bf16 v[136:151], v[176:179], v[180:183], v[136:151]
    ds_read_b64_tr_b16 v[48:49], v13 offset:64
    ds_read_b64_tr_b16 v[50:51], v13 offset:1600
    v_mfma_f32_32x32x16_bf16 v[152:167], v[176:179], v[184:187], v[152:167]
    buffer_load_dwordx4 a[60:63], v243, s[48:51], s89 offen offset:2048 sc1
    s_waitcnt lgkmcnt(6)
    v_mfma_f32_32x32x16_bf16 v[72:87], v[40:43], v[52:55], v[72:87]
    ds_read_b64_tr_b16 v[180:181], v16 offset:4096
    ds_read_b64_tr_b16 v[182:183], v16 offset:6144
    s_waitcnt lgkmcnt(6)
    v_mfma_f32_32x32x16_bf16 v[88:103], v[40:43], v[56:59], v[88:103]
    ds_read_b64_tr_b16 v[168:169], v13 offset:6208
    ds_read_b64_tr_b16 v[170:171], v13 offset:7744
    s_waitcnt lgkmcnt(6)
    v_mfma_f32_32x32x16_bf16 v[104:119], v[44:47], v[52:55], v[104:119]
    ds_read_b64_tr_b16 v[184:185], v17 offset:4096
    ds_read_b64_tr_b16 v[186:187], v17 offset:6144
    v_mfma_f32_32x32x16_bf16 v[120:135], v[44:47], v[56:59], v[120:135]
    ds_read_b64_tr_b16 v[172:173], v13 offset:6240
    ds_read_b64_tr_b16 v[174:175], v13 offset:7776
    s_waitcnt lgkmcnt(8)
    v_mfma_f32_32x32x16_bf16 v[136:151], v[48:51], v[52:55], v[136:151]
    ds_read_b64_tr_b16 v[176:177], v13 offset:6272
    ds_read_b64_tr_b16 v[178:179], v13 offset:7808
    v_mfma_f32_32x32x16_bf16 v[152:167], v[48:51], v[56:59], v[152:167]
    s_mov_b32 s89, 8192
    s_waitcnt lgkmcnt(6)
    v_mfma_f32_32x32x16_bf16 v[72:87], v[168:171], v[180:183], v[72:87]
    buffer_load_dwordx4 a[64:67], v244, s[48:51], s89 offen offset:0 sc1
    ds_read_b64_tr_b16 v[52:53], v16 offset:8192
    ds_read_b64_tr_b16 v[54:55], v16 offset:10240
    s_waitcnt lgkmcnt(6)
    v_mfma_f32_32x32x16_bf16 v[88:103], v[168:171], v[184:187], v[88:103]
    buffer_load_dwordx4 a[68:71], v243, s[48:51], s89 offen offset:0 sc1
    s_lshl_b32 s4, s81, 6
    ds_read_b64_tr_b16 v[40:41], v13 offset:12416
    ds_read_b64_tr_b16 v[42:43], v13 offset:13952
    s_waitcnt lgkmcnt(6)
    v_mfma_f32_32x32x16_bf16 v[104:119], v[172:175], v[180:183], v[104:119]
    s_lshl_b32 s5, s76, 5
    s_add_u32 s4, s4, s5
    ds_read_b64_tr_b16 v[56:57], v17 offset:8192
    ds_read_b64_tr_b16 v[58:59], v17 offset:10240
    v_mfma_f32_32x32x16_bf16 v[120:135], v[172:175], v[184:187], v[120:135]
    s_lshl_b32 s4, s4, 12
    s_lshl_b32 s5, s80, 7
    ds_read_b64_tr_b16 v[44:45], v13 offset:12448
    ds_read_b64_tr_b16 v[46:47], v13 offset:13984
    s_waitcnt lgkmcnt(8)
    v_mfma_f32_32x32x16_bf16 v[136:151], v[176:179], v[180:183], v[136:151]
    s_add_u32 s4, s4, s5
    s_lshl_b32 s5, s77, 6
    ds_read_b64_tr_b16 v[48:49], v13 offset:12480
    ds_read_b64_tr_b16 v[50:51], v13 offset:14016
    v_mfma_f32_32x32x16_bf16 v[152:167], v[176:179], v[184:187], v[152:167]
    s_add_u32 s4, s4, s5
    s_add_u32 s4, s4, 1048576
    s_waitcnt lgkmcnt(6)
    v_mfma_f32_32x32x16_bf16 v[72:87], v[40:43], v[52:55], v[72:87]
    s_mov_b32 s89, 12288
    ds_read_b64_tr_b16 v[180:181], v16 offset:12288
    ds_read_b64_tr_b16 v[182:183], v16 offset:14336
    s_waitcnt lgkmcnt(6)
    v_mfma_f32_32x32x16_bf16 v[88:103], v[40:43], v[56:59], v[88:103]
    v_lshrrev_b32 v8, 2, v1
    v_and_b32 v9, 3, v1
    ds_read_b64_tr_b16 v[168:169], v13 offset:18624
    ds_read_b64_tr_b16 v[170:171], v13 offset:20160
    s_waitcnt lgkmcnt(6)
    v_mfma_f32_32x32x16_bf16 v[104:119], v[44:47], v[52:55], v[104:119]
    v_lshlrev_b32 v9, 4, v9
    v_lshl_add_u32 v8, v8, 12, v9
    ds_read_b64_tr_b16 v[184:185], v17 offset:12288
    ds_read_b64_tr_b16 v[186:187], v17 offset:14336
    v_mfma_f32_32x32x16_bf16 v[120:135], v[44:47], v[56:59], v[120:135]
    s_lshl_b32 s5, s72, 11
    ds_read_b64_tr_b16 v[172:173], v13 offset:18656
    ds_read_b64_tr_b16 v[174:175], v13 offset:20192
    s_waitcnt lgkmcnt(8)
    v_mfma_f32_32x32x16_bf16 v[136:151], v[48:51], v[52:55], v[136:151]
    s_add_u32 m0, s5, 57600
    s_add_u32 s7, s4, 64512
    ds_read_b64_tr_b16 v[176:177], v13 offset:18688
    ds_read_b64_tr_b16 v[178:179], v13 offset:20224
    v_mfma_f32_32x32x16_bf16 v[152:167], v[48:51], v[56:59], v[152:167]
    buffer_load_dwordx4 v8, s[48:51], s4 offen sc1 lds
    buffer_load_dwordx4 v8, s[48:51], s7 offen offset:1024 sc1 lds
    s_waitcnt lgkmcnt(0)
    s_waitcnt vmcnt(8)
    s_barrier
    v_mfma_f32_32x32x16_bf16 v[72:87], v[168:171], v[180:183], v[72:87]
    buffer_load_dwordx4 a[72:75], v244, s[48:51], s89 offen offset:2048 sc1
    buffer_load_dwordx4 a[76:79], v243, s[48:51], s89 offen offset:2048 sc1
    ds_read_b64_tr_b16 a[224:225], v18 offset:0
    ds_read_b64_tr_b16 a[226:227], v18 offset:2048
    v_mfma_f32_32x32x16_bf16 v[88:103], v[168:171], v[184:187], v[88:103]
    v_bfe_u32 v9, v1, 2, 3
    v_lshlrev_b32 v9, 5, v9
    ds_read_b64_tr_b16 a[176:177], v14 offset:0
    ds_read_b64_tr_b16 a[178:179], v14 offset:1536
    v_mfma_f32_32x32x16_bf16 v[104:119], v[172:175], v[180:183], v[104:119]
    v_and_b32 v10, 3, v1
    v_lshl_add_u32 v10, v10, 9, v9
    ds_read_b64_tr_b16 a[228:229], v18 offset:4096
    ds_read_b64_tr_b16 a[230:231], v18 offset:6144
    v_mfma_f32_32x32x16_bf16 v[120:135], v[172:175], v[184:187], v[120:135]
    s_lshl_b32 s6, s81, 11
    s_lshl_b32 s7, s76, 8
    ds_read_b64_tr_b16 a[180:181], v14 offset:6208
    ds_read_b64_tr_b16 a[182:183], v14 offset:7744
    v_mfma_f32_32x32x16_bf16 v[136:151], v[176:179], v[180:183], v[136:151]
    s_add_u32 s6, s6, s7
    s_add_u32 s6, s6, 606208
    ds_read_b64_tr_b16 a[232:233], v18 offset:8192
    ds_read_b64_tr_b16 a[234:235], v18 offset:10240
    v_mfma_f32_32x32x16_bf16 v[152:167], v[176:179], v[184:187], v[152:167]
    buffer_load_dwordx2 v[36:37], v10, s[48:51], s6 offen sc1
    buffer_load_dwordx2 v[38:39], v10, s[48:51], s6 offen offset:16 sc1
    ds_read_b64_tr_b16 a[184:185], v14 offset:12416
    ds_read_b64_tr_b16 a[186:187], v14 offset:13952
    ds_read_b64_tr_b16 a[236:237], v18 offset:12288
    ds_read_b64_tr_b16 a[238:239], v18 offset:14336
    ds_read_b64_tr_b16 a[188:189], v14 offset:18624
    ds_read_b64_tr_b16 a[190:191], v14 offset:20160
    s_waitcnt vmcnt(11)
    v_cmp_ne_u32 vcc, s100, v61
    s_waitcnt vmcnt(10)
    v_cmp_ne_u32 s[12:13], s100, v63
    s_or_b64 vcc, vcc, s[12:13]
    s_cbranch_vccz Lskip_41
    s_mov_b32 s88, 0
Lbs_39:
    buffer_load_dwordx2 v[60:61], v12, s[48:51], 0 offen offset:0 sc1
    buffer_load_dwordx2 v[62:63], v12, s[48:51], 0 offen offset:256 sc1
    s_add_u32 s88, s88, 1
    s_waitcnt vmcnt(0)
    v_cmp_ne_u32 vcc, s100, v61
    v_cmp_ne_u32 s[12:13], s100, v63
    s_or_b64 vcc, vcc, s[12:13]
    s_cmp_gt_u32 s88, 0x40000
    s_cbranch_scc1 Lbsd_40
    s_cbranch_vccnz Lbs_39
Lbsd_40:
Lskip_41:
    s_waitcnt lgkmcnt(12)
    v_mfma_f32_32x32x16_bf16 v[72:87], a[176:179], a[224:227], v[72:87]
    ds_read_b64_tr_b16 v[40:41], v22 offset:0
    ds_read_b64_tr_b16 v[42:43], v22 offset:512
    s_mov_b32 s8, 0x01000100
    s_mov_b32 s9, 0x03020302
    v_perm_b32 v52, v60, v60, s8
    v_perm_b32 v53, v60, v60, s9
    v_perm_b32 v54, v60, v60, s8
    v_perm_b32 v55, v60, v60, s9
    v_perm_b32 v56, v62, v62, s8
    v_perm_b32 v57, v62, v62, s9
    v_perm_b32 v58, v62, v62, s8
    s_waitcnt lgkmcnt(10)
    v_mfma_f32_32x32x16_bf16 v[72:87], a[180:183], a[228:231], v[72:87]
    v_perm_b32 v59, v62, v62, s9
    ds_read_b64_tr_b16 a[240:241], v19 offset:0
    ds_read_b64_tr_b16 a[242:243], v19 offset:2048
    ds_read_b64_tr_b16 a[244:245], v19 offset:4096
    ds_read_b64_tr_b16 a[246:247], v19 offset:6144
    ds_read_b64_tr_b16 a[248:249], v19 offset:8192
    ds_read_b64_tr_b16 a[250:251], v19 offset:10240
    ds_read_b64_tr_b16 a[252:253], v19 offset:12288
    ds_read_b64_tr_b16 a[254:255], v19 offset:14336
    v_and_b32 v190, 0xffff0000, v60
    v_rcp_f32 v191, v190
    v_mul_f32 v190, v190, v190
    s_waitcnt lgkmcnt(14)
    v_mfma_f32_32x32x16_bf16 v[72:87], a[184:187], a[232:235], v[72:87]
    v_mul_f32 v188, 0xc0135761, v191
    v_mul_f32 v189, v191, v191
    v_mul_f32 v189, v189, v191
    v_mul_f32 v189, 0xbdd2d3e8, v189
    v_and_b32 v194, 0xffff0000, v62
    v_rcp_f32 v195, v194
    v_mul_f32 v194, v194, v194
    v_mul_f32 v192, 0xc0135761, v195
    v_mul_f32 v193, v195, v195
    v_mul_f32 v193, v193, v195
    v_mul_f32 v193, 0xbdd2d3e8, v193
    s_waitcnt lgkmcnt(10)
    v_mfma_f32_32x32x16_bf16 v[72:87], a[188:191], a[236:239], v[72:87]
    v_lshlrev_b32 v12, 4, v1
    s_lshl_b32 s4, s25, 2
    s_lshl_b32 s5, s76, 1
    s_add_u32 s4, s4, s5
    s_mul_i32 s4, s4, 88064
    s_mul_i32 s6, s26, 6
    s_mul_i32 s5, s77, 3
    s_add_u32 s6, s6, s5
    s_lshl_b32 s5, s6, 10
    s_add_u32 s4, s4, s5
    s_add_u32 s4, s4, 10485760
    s_add_u32 s5, s4, 88064
    s_waitcnt lgkmcnt(8)
    v_mfma_f32_32x32x16_bf16 v[72:87], v[40:43], v[52:55], v[72:87]
    s_nop 11
    v_pk_mul_f32 v[196:197], v[72:73], v[72:73]
    v_pk_mul_f32 v[198:199], v[74:75], v[74:75]
    ds_read_b64_tr_b16 a[192:193], v14 offset:32
    v_pk_mul_f32 v[200:201], v[76:77], v[76:77]
    v_pk_mul_f32 v[202:203], v[78:79], v[78:79]
    ds_read_b64_tr_b16 a[194:195], v14 offset:1568
    v_pk_fma_f32 v[196:197], v[196:197], v[188:189], v[188:189] op_sel:[0,1,0] op_sel_hi:[1,1,0]
    ds_read_b64_tr_b16 a[196:197], v14 offset:6240
    v_pk_fma_f32 v[198:199], v[198:199], v[188:189], v[188:189] op_sel:[0,1,0] op_sel_hi:[1,1,0]
    v_pk_fma_f32 v[200:201], v[200:201], v[188:189], v[188:189] op_sel:[0,1,0] op_sel_hi:[1,1,0]
    ds_read_b64_tr_b16 a[198:199], v14 offset:7776
    v_pk_fma_f32 v[202:203], v[202:203], v[188:189], v[188:189] op_sel:[0,1,0] op_sel_hi:[1,1,0]
    ds_read_b64_tr_b16 a[200:201], v14 offset:12448
    v_pk_mul_f32 v[196:197], v[196:197], v[72:73]
    v_pk_mul_f32 v[198:199], v[198:199], v[74:75]
    ds_read_b64_tr_b16 a[202:203], v14 offset:13984
    v_pk_mul_f32 v[200:201], v[200:201], v[76:77]
    v_pk_mul_f32 v[202:203], v[202:203], v[78:79]
    ds_read_b64_tr_b16 a[204:205], v14 offset:18656
    v_pk_mul_f32 v[204:205], v[72:73], v[80:81]
    ds_read_b64_tr_b16 a[206:207], v14 offset:20192
    v_pk_mul_f32 v[206:207], v[74:75], v[82:83]
    v_pk_mul_f32 v[208:209], v[76:77], v[84:85]
    ds_read_b64_tr_b16 v[44:45], v22 offset:1024
    v_pk_mul_f32 v[210:211], v[78:79], v[86:87]
    ds_read_b64_tr_b16 v[46:47], v22 offset:1536
    s_waitcnt lgkmcnt(15)
    v_mfma_f32_32x32x16_bf16 v[88:103], a[176:179], a[240:243], v[88:103]
    v_exp_f32 v196, v196
    v_exp_f32 v197, v197
    v_exp_f32 v198, v198
    v_exp_f32 v199, v199
    s_mov_b32 s89, 20480
    s_waitcnt lgkmcnt(14)
    v_mfma_f32_32x32x16_bf16 v[88:103], a[180:183], a[244:247], v[88:103]
    v_exp_f32 v200, v200
    v_exp_f32 v201, v201
    v_exp_f32 v202, v202
    v_exp_f32 v203, v203
    buffer_load_dwordx4 a[80:83], v244, s[48:51], s89 offen offset:0 sc1
    s_waitcnt lgkmcnt(12)
    v_mfma_f32_32x32x16_bf16 v[88:103], a[184:187], a[248:251], v[88:103]
    v_fma_f32 v196, v196, v190, v190
    v_fma_f32 v197, v197, v190, v190
    v_fma_f32 v198, v198, v190, v190
    v_fma_f32 v199, v199, v190, v190
    v_fma_f32 v200, v200, v190, v190
    v_fma_f32 v201, v201, v190, v190
    v_fma_f32 v202, v202, v190, v190
    v_fma_f32 v203, v203, v190, v190
    s_waitcnt lgkmcnt(10)
    v_mfma_f32_32x32x16_bf16 v[88:103], a[188:191], a[252:255], v[88:103]
    v_rcp_f32 v196, v196
    v_rcp_f32 v197, v197
    v_rcp_f32 v198, v198
    v_rcp_f32 v199, v199
    buffer_load_dwordx4 a[84:87], v243, s[48:51], s89 offen offset:0 sc1
    v_mfma_f32_32x32x16_bf16 v[88:103], v[40:43], v[56:59], v[88:103]
    v_rcp_f32 v200, v200
    v_rcp_f32 v201, v201
    v_rcp_f32 v202, v202
    s_mov_b32 s89, 24576
    v_rcp_f32 v203, v203
    v_pk_mul_f32 v[204:205], v[204:205], v[196:197]
    v_pk_mul_f32 v[206:207], v[206:207], v[198:199]
    v_pk_mul_f32 v[208:209], v[208:209], v[200:201]
    v_pk_mul_f32 v[210:211], v[210:211], v[202:203]
    v_cvt_pk_bf16_f32 v64, v204, v205
    v_cvt_pk_bf16_f32 v65, v206, v207
    v_cvt_pk_bf16_f32 v66, v208, v209
    v_cvt_pk_bf16_f32 v67, v210, v211
    s_add_u32 s7, s6, 0
    s_cmp_ge_u32 s7, 86
    s_cbranch_scc1 Lskip_42
    buffer_store_dwordx4 v[64:67], v12, s[48:51], s4 offen offset:0 sc1
Lskip_42:
    v_pk_mul_f32 v[196:197], v[88:89], v[88:89]
    v_pk_mul_f32 v[198:199], v[90:91], v[90:91]
    v_pk_mul_f32 v[200:201], v[92:93], v[92:93]
    v_pk_mul_f32 v[202:203], v[94:95], v[94:95]
    v_pk_fma_f32 v[196:197], v[196:197], v[192:193], v[192:193] op_sel:[0,1,0] op_sel_hi:[1,1,0]
    v_pk_fma_f32 v[198:199], v[198:199], v[192:193], v[192:193] op_sel:[0,1,0] op_sel_hi:[1,1,0]
    v_pk_fma_f32 v[200:201], v[200:201], v[192:193], v[192:193] op_sel:[0,1,0] op_sel_hi:[1,1,0]
    v_pk_fma_f32 v[202:203], v[202:203], v[192:193], v[192:193] op_sel:[0,1,0] op_sel_hi:[1,1,0]
    v_pk_mul_f32 v[196:197], v[196:197], v[88:89]
    v_pk_mul_f32 v[198:199], v[198:199], v[90:91]
    v_pk_mul_f32 v[200:201], v[200:201], v[92:93]
    v_pk_mul_f32 v[202:203], v[202:203], v[94:95]
    v_pk_mul_f32 v[204:205], v[88:89], v[96:97]
    v_pk_mul_f32 v[206:207], v[90:91], v[98:99]
    v_pk_mul_f32 v[208:209], v[92:93], v[100:101]
    v_pk_mul_f32 v[210:211], v[94:95], v[102:103]
    s_waitcnt lgkmcnt(8)
    v_mfma_f32_32x32x16_bf16 v[104:119], a[192:195], a[224:227], v[104:119]
    v_exp_f32 v196, v196
    v_exp_f32 v197, v197
    v_exp_f32 v198, v198
    buffer_load_dwordx4 a[88:91], v244, s[48:51], s89 offen offset:2048 sc1
    v_exp_f32 v199, v199
    s_waitcnt lgkmcnt(6)
    v_mfma_f32_32x32x16_bf16 v[104:119], a[196:199], a[228:231], v[104:119]
    v_exp_f32 v200, v200
    v_exp_f32 v201, v201
    v_exp_f32 v202, v202
    buffer_load_dwordx4 a[92:95], v243, s[48:51], s89 offen offset:2048 sc1
    v_exp_f32 v203, v203
    s_waitcnt lgkmcnt(4)
    v_mfma_f32_32x32x16_bf16 v[104:119], a[200:203], a[232:235], v[104:119]
    v_fma_f32 v196, v196, v194, v194
    v_fma_f32 v197, v197, v194, v194
    v_fma_f32 v198, v198, v194, v194
    v_fma_f32 v199, v199, v194, v194
    v_fma_f32 v200, v200, v194, v194
    v_fma_f32 v201, v201, v194, v194
    v_fma_f32 v202, v202, v194, v194
    v_fma_f32 v203, v203, v194, v194
    s_waitcnt lgkmcnt(2)
    v_mfma_f32_32x32x16_bf16 v[104:119], a[204:207], a[236:239], v[104:119]
    v_rcp_f32 v196, v196
    v_rcp_f32 v197, v197
    v_rcp_f32 v198, v198
    s_mov_b32 s89, 32768
    v_rcp_f32 v199, v199
    s_waitcnt lgkmcnt(0)
    v_mfma_f32_32x32x16_bf16 v[104:119], v[44:47], v[52:55], v[104:119]
    v_rcp_f32 v200, v200
    v_rcp_f32 v201, v201
    buffer_load_dwordx4 a[96:99], v244, s[48:51], s89 offen offset:0 sc1
    v_rcp_f32 v202, v202
    v_rcp_f32 v203, v203
    v_pk_mul_f32 v[204:205], v[204:205], v[196:197]
    v_pk_mul_f32 v[206:207], v[206:207], v[198:199]
    v_pk_mul_f32 v[208:209], v[208:209], v[200:201]
    v_pk_mul_f32 v[210:211], v[210:211], v[202:203]
    v_cvt_pk_bf16_f32 v212, v204, v205
    v_cvt_pk_bf16_f32 v213, v206, v207
    v_cvt_pk_bf16_f32 v214, v208, v209
    v_cvt_pk_bf16_f32 v215, v210, v211
    s_add_u32 s7, s6, 0
    s_cmp_ge_u32 s7, 86
    s_cbranch_scc1 Lskip_43
    buffer_store_dwordx4 v[212:215], v12, s[48:51], s5 offen offset:0 sc1
Lskip_43:
    v_pk_mul_f32 v[196:197], v[104:105], v[104:105]
    v_pk_mul_f32 v[198:199], v[106:107], v[106:107]
    ds_read_b64_tr_b16 a[208:209], v14 offset:64
    v_pk_mul_f32 v[200:201], v[108:109], v[108:109]
    v_pk_mul_f32 v[202:203], v[110:111], v[110:111]
    ds_read_b64_tr_b16 a[210:211], v14 offset:1600
    v_pk_fma_f32 v[196:197], v[196:197], v[188:189], v[188:189] op_sel:[0,1,0] op_sel_hi:[1,1,0]
    ds_read_b64_tr_b16 a[212:213], v14 offset:6272
    v_pk_fma_f32 v[198:199], v[198:199], v[188:189], v[188:189] op_sel:[0,1,0] op_sel_hi:[1,1,0]
    v_pk_fma_f32 v[200:201], v[200:201], v[188:189], v[188:189] op_sel:[0,1,0] op_sel_hi:[1,1,0]
    ds_read_b64_tr_b16 a[214:215], v14 offset:7808
    v_pk_fma_f32 v[202:203], v[202:203], v[188:189], v[188:189] op_sel:[0,1,0] op_sel_hi:[1,1,0]
    ds_read_b64_tr_b16 a[216:217], v14 offset:12480
    v_pk_mul_f32 v[196:197], v[196:197], v[104:105]
    v_pk_mul_f32 v[198:199], v[198:199], v[106:107]
    ds_read_b64_tr_b16 a[218:219], v14 offset:14016
    v_pk_mul_f32 v[200:201], v[200:201], v[108:109]
    v_pk_mul_f32 v[202:203], v[202:203], v[110:111]
    ds_read_b64_tr_b16 a[220:221], v14 offset:18688
    v_pk_mul_f32 v[204:205], v[104:105], v[112:113]
    ds_read_b64_tr_b16 a[222:223], v14 offset:20224
    v_pk_mul_f32 v[206:207], v[106:107], v[114:115]
    v_pk_mul_f32 v[208:209], v[108:109], v[116:117]
    ds_read_b64_tr_b16 v[48:49], v22 offset:2048
    v_pk_mul_f32 v[210:211], v[110:111], v[118:119]
    ds_read_b64_tr_b16 v[50:51], v22 offset:2560
    v_mfma_f32_32x32x16_bf16 v[120:135], a[192:195], a[240:243], v[120:135]
    v_exp_f32 v196, v196
    v_exp_f32 v197, v197
    buffer_load_dwordx4 a[100:103], v243, s[48:51], s89 offen offset:0 sc1
    v_exp_f32 v198, v198
    v_exp_f32 v199, v199
    v_mfma_f32_32x32x16_bf16 v[120:135], a[196:199], a[244:247], v[120:135]
    v_exp_f32 v200, v200
    v_exp_f32 v201, v201
    s_mov_b32 s89, 36864
    v_exp_f32 v202, v202
    v_exp_f32 v203, v203
    v_mfma_f32_32x32x16_bf16 v[120:135], a[200:203], a[248:251], v[120:135]
    v_fma_f32 v196, v196, v190, v190
    v_fma_f32 v197, v197, v190, v190
    v_fma_f32 v198, v198, v190, v190
    v_fma_f32 v199, v199, v190, v190
    v_fma_f32 v200, v200, v190, v190
    v_fma_f32 v201, v201, v190, v190
    v_fma_f32 v202, v202, v190, v190
    v_fma_f32 v203, v203, v190, v190
    v_mfma_f32_32x32x16_bf16 v[120:135], a[204:207], a[252:255], v[120:135]
    v_rcp_f32 v196, v196
    v_rcp_f32 v197, v197
    buffer_load_dwordx4 a[104:107], v244, s[48:51], s89 offen offset:2048 sc1
    v_rcp_f32 v198, v198
    v_rcp_f32 v199, v199
    v_mfma_f32_32x32x16_bf16 v[120:135], v[44:47], v[56:59], v[120:135]
    v_rcp_f32 v200, v200
    buffer_load_dwordx4 a[108:111], v243, s[48:51], s89 offen offset:2048 sc1
    v_rcp_f32 v201, v201
    v_rcp_f32 v202, v202
    v_rcp_f32 v203, v203
    v_pk_mul_f32 v[204:205], v[204:205], v[196:197]
    v_pk_mul_f32 v[206:207], v[206:207], v[198:199]
    v_pk_mul_f32 v[208:209], v[208:209], v[200:201]
    v_pk_mul_f32 v[210:211], v[210:211], v[202:203]
    v_cvt_pk_bf16_f32 v64, v204, v205
    v_cvt_pk_bf16_f32 v65, v206, v207
    v_cvt_pk_bf16_f32 v66, v208, v209
    v_cvt_pk_bf16_f32 v67, v210, v211
    s_add_u32 s7, s6, 1
    s_cmp_ge_u32 s7, 86
    s_cbranch_scc1 Lskip_44
    buffer_store_dwordx4 v[64:67], v12, s[48:51], s4 offen offset:1024 sc1
Lskip_44:
    v_pk_mul_f32 v[196:197], v[120:121], v[120:121]
    v_pk_mul_f32 v[198:199], v[122:123], v[122:123]
    v_pk_mul_f32 v[200:201], v[124:125], v[124:125]
    v_pk_mul_f32 v[202:203], v[126:127], v[126:127]
    v_pk_fma_f32 v[196:197], v[196:197], v[192:193], v[192:193] op_sel:[0,1,0] op_sel_hi:[1,1,0]
    v_pk_fma_f32 v[198:199], v[198:199], v[192:193], v[192:193] op_sel:[0,1,0] op_sel_hi:[1,1,0]
    v_pk_fma_f32 v[200:201], v[200:201], v[192:193], v[192:193] op_sel:[0,1,0] op_sel_hi:[1,1,0]
    v_pk_fma_f32 v[202:203], v[202:203], v[192:193], v[192:193] op_sel:[0,1,0] op_sel_hi:[1,1,0]
    v_pk_mul_f32 v[196:197], v[196:197], v[120:121]
    v_pk_mul_f32 v[198:199], v[198:199], v[122:123]
    v_pk_mul_f32 v[200:201], v[200:201], v[124:125]
    v_pk_mul_f32 v[202:203], v[202:203], v[126:127]
    v_pk_mul_f32 v[204:205], v[120:121], v[128:129]
    v_pk_mul_f32 v[206:207], v[122:123], v[130:131]
    v_pk_mul_f32 v[208:209], v[124:125], v[132:133]
    v_pk_mul_f32 v[210:211], v[126:127], v[134:135]
    s_waitcnt lgkmcnt(8)
    v_mfma_f32_32x32x16_bf16 v[136:151], a[208:211], a[224:227], v[136:151]
    v_exp_f32 v196, v196
    s_mov_b32 s89, 4096
    v_exp_f32 v197, v197
    v_exp_f32 v198, v198
    v_exp_f32 v199, v199
    s_waitcnt lgkmcnt(6)
    v_mfma_f32_32x32x16_bf16 v[136:151], a[212:215], a[228:231], v[136:151]
    v_exp_f32 v200, v200
    buffer_load_dwordx4 a[112:115], v244, s[48:51], s89 offen offset:0 sc1
    v_exp_f32 v201, v201
    v_exp_f32 v202, v202
    v_exp_f32 v203, v203
    s_waitcnt lgkmcnt(4)
    v_mfma_f32_32x32x16_bf16 v[136:151], a[216:219], a[232:235], v[136:151]
    v_fma_f32 v196, v196, v194, v194
    v_fma_f32 v197, v197, v194, v194
    v_fma_f32 v198, v198, v194, v194
    v_fma_f32 v199, v199, v194, v194
    v_fma_f32 v200, v200, v194, v194
    v_fma_f32 v201, v201, v194, v194
    v_fma_f32 v202, v202, v194, v194
    v_fma_f32 v203, v203, v194, v194
    s_waitcnt lgkmcnt(2)
    v_mfma_f32_32x32x16_bf16 v[136:151], a[220:223], a[236:239], v[136:151]
    v_rcp_f32 v196, v196
    buffer_load_dwordx4 a[116:119], v243, s[48:51], s89 offen offset:0 sc1
    v_rcp_f32 v197, v197
    v_rcp_f32 v198, v198
    v_rcp_f32 v199, v199
    s_mov_b32 s89, 8192
    s_waitcnt lgkmcnt(0)
    v_mfma_f32_32x32x16_bf16 v[136:151], v[48:51], v[52:55], v[136:151]
    v_rcp_f32 v200, v200
    v_rcp_f32 v201, v201
    v_rcp_f32 v202, v202
    v_rcp_f32 v203, v203
    buffer_load_dwordx4 a[120:123], v244, s[48:51], s89 offen offset:2048 sc1
    v_pk_mul_f32 v[204:205], v[204:205], v[196:197]
    v_pk_mul_f32 v[206:207], v[206:207], v[198:199]
    v_pk_mul_f32 v[208:209], v[208:209], v[200:201]
    v_pk_mul_f32 v[210:211], v[210:211], v[202:203]
    v_cvt_pk_bf16_f32 v212, v204, v205
    v_cvt_pk_bf16_f32 v213, v206, v207
    v_cvt_pk_bf16_f32 v214, v208, v209
    v_cvt_pk_bf16_f32 v215, v210, v211
    s_add_u32 s7, s6, 1
    s_cmp_ge_u32 s7, 86
    s_cbranch_scc1 Lskip_45
    buffer_store_dwordx4 v[212:215], v12, s[48:51], s5 offen offset:1024 sc1
Lskip_45:
    v_pk_mul_f32 v[196:197], v[136:137], v[136:137]
    v_pk_mul_f32 v[198:199], v[138:139], v[138:139]
    v_pk_mul_f32 v[200:201], v[140:141], v[140:141]
    v_pk_mul_f32 v[202:203], v[142:143], v[142:143]
    v_pk_fma_f32 v[196:197], v[196:197], v[188:189], v[188:189] op_sel:[0,1,0] op_sel_hi:[1,1,0]
    v_pk_fma_f32 v[198:199], v[198:199], v[188:189], v[188:189] op_sel:[0,1,0] op_sel_hi:[1,1,0]
    v_pk_fma_f32 v[200:201], v[200:201], v[188:189], v[188:189] op_sel:[0,1,0] op_sel_hi:[1,1,0]
    v_pk_fma_f32 v[202:203], v[202:203], v[188:189], v[188:189] op_sel:[0,1,0] op_sel_hi:[1,1,0]
    v_pk_mul_f32 v[196:197], v[196:197], v[136:137]
    v_pk_mul_f32 v[198:199], v[198:199], v[138:139]
    v_pk_mul_f32 v[200:201], v[200:201], v[140:141]
    v_pk_mul_f32 v[202:203], v[202:203], v[142:143]
    v_pk_mul_f32 v[204:205], v[136:137], v[144:145]
    v_pk_mul_f32 v[206:207], v[138:139], v[146:147]
    v_pk_mul_f32 v[208:209], v[140:141], v[148:149]
    v_pk_mul_f32 v[210:211], v[142:143], v[150:151]
    v_mfma_f32_32x32x16_bf16 v[152:167], a[208:211], a[240:243], v[152:167]
    v_exp_f32 v196, v196
    v_exp_f32 v197, v197
    v_exp_f32 v198, v198
    v_exp_f32 v199, v199
    buffer_load_dwordx4 a[124:127], v243, s[48:51], s89 offen offset:2048 sc1
    v_mfma_f32_32x32x16_bf16 v[152:167], a[212:215], a[244:247], v[152:167]
    v_exp_f32 v200, v200
    v_exp_f32 v201, v201
    v_exp_f32 v202, v202
    v_exp_f32 v203, v203
    s_mov_b32 s89, 16384
    v_mfma_f32_32x32x16_bf16 v[152:167], a[216:219], a[248:251], v[152:167]
    v_fma_f32 v196, v196, v190, v190
    v_fma_f32 v197, v197, v190, v190
    v_fma_f32 v198, v198, v190, v190
    v_fma_f32 v199, v199, v190, v190
    v_fma_f32 v200, v200, v190, v190
    v_fma_f32 v201, v201, v190, v190
    v_fma_f32 v202, v202, v190, v190
    v_fma_f32 v203, v203, v190, v190
    v_mfma_f32_32x32x16_bf16 v[152:167], a[220:223], a[252:255], v[152:167]
    v_rcp_f32 v196, v196
    v_rcp_f32 v197, v197
    v_rcp_f32 v198, v198
    buffer_load_dwordx4 a[128:131], v244, s[48:51], s89 offen offset:0 sc1
    v_rcp_f32 v199, v199
    v_mfma_f32_32x32x16_bf16 v[152:167], v[48:51], v[56:59], v[152:167]
    v_rcp_f32 v200, v200
    v_rcp_f32 v201, v201
    v_rcp_f32 v202, v202
    buffer_load_dwordx4 a[132:135], v243, s[48:51], s89 offen offset:0 sc1
    v_rcp_f32 v203, v203
    v_pk_mul_f32 v[204:205], v[204:205], v[196:197]
    v_pk_mul_f32 v[206:207], v[206:207], v[198:199]
    v_pk_mul_f32 v[208:209], v[208:209], v[200:201]
    v_pk_mul_f32 v[210:211], v[210:211], v[202:203]
    v_cvt_pk_bf16_f32 v64, v204, v205
    v_cvt_pk_bf16_f32 v65, v206, v207
    v_cvt_pk_bf16_f32 v66, v208, v209
    v_cvt_pk_bf16_f32 v67, v210, v211
    s_add_u32 s7, s6, 2
    s_cmp_ge_u32 s7, 86
    s_cbranch_scc1 Lskip_46
    buffer_store_dwordx4 v[64:67], v12, s[48:51], s4 offen offset:2048 sc1
Lskip_46:
    v_pk_mul_f32 v[196:197], v[152:153], v[152:153]
    v_pk_mul_f32 v[198:199], v[154:155], v[154:155]
    v_pk_mul_f32 v[200:201], v[156:157], v[156:157]
    v_pk_mul_f32 v[202:203], v[158:159], v[158:159]
    v_pk_fma_f32 v[196:197], v[196:197], v[192:193], v[192:193] op_sel:[0,1,0] op_sel_hi:[1,1,0]
    v_pk_fma_f32 v[198:199], v[198:199], v[192:193], v[192:193] op_sel:[0,1,0] op_sel_hi:[1,1,0]
    v_pk_fma_f32 v[200:201], v[200:201], v[192:193], v[192:193] op_sel:[0,1,0] op_sel_hi:[1,1,0]
    v_pk_fma_f32 v[202:203], v[202:203], v[192:193], v[192:193] op_sel:[0,1,0] op_sel_hi:[1,1,0]
    v_pk_mul_f32 v[196:197], v[196:197], v[152:153]
    v_pk_mul_f32 v[198:199], v[198:199], v[154:155]
    v_pk_mul_f32 v[200:201], v[200:201], v[156:157]
    v_pk_mul_f32 v[202:203], v[202:203], v[158:159]
    v_pk_mul_f32 v[204:205], v[152:153], v[160:161]
    v_pk_mul_f32 v[206:207], v[154:155], v[162:163]
    v_pk_mul_f32 v[208:209], v[156:157], v[164:165]
    v_pk_mul_f32 v[210:211], v[158:159], v[166:167]
    v_exp_f32 v196, v196
    v_exp_f32 v197, v197
    v_exp_f32 v198, v198
    s_mov_b32 s89, 20480
    v_exp_f32 v199, v199
    v_exp_f32 v200, v200
    v_exp_f32 v201, v201
    v_exp_f32 v202, v202
    buffer_load_dwordx4 a[136:139], v244, s[48:51], s89 offen offset:2048 sc1
    v_exp_f32 v203, v203
    v_pk_fma_f32 v[196:197], v[196:197], v[194:195], v[194:195] op_sel_hi:[1,0,0]
    v_pk_fma_f32 v[198:199], v[198:199], v[194:195], v[194:195] op_sel_hi:[1,0,0]
    v_pk_fma_f32 v[200:201], v[200:201], v[194:195], v[194:195] op_sel_hi:[1,0,0]
    v_pk_fma_f32 v[202:203], v[202:203], v[194:195], v[194:195] op_sel_hi:[1,0,0]
    v_rcp_f32 v196, v196
    v_rcp_f32 v197, v197
    buffer_load_dwordx4 a[140:143], v243, s[48:51], s89 offen offset:2048 sc1
    v_rcp_f32 v198, v198
    v_rcp_f32 v199, v199
    v_rcp_f32 v200, v200
    v_rcp_f32 v201, v201
    v_rcp_f32 v202, v202
    v_rcp_f32 v203, v203
    v_pk_mul_f32 v[204:205], v[204:205], v[196:197]
    v_pk_mul_f32 v[206:207], v[206:207], v[198:199]
    v_pk_mul_f32 v[208:209], v[208:209], v[200:201]
    v_pk_mul_f32 v[210:211], v[210:211], v[202:203]
    v_cvt_pk_bf16_f32 v212, v204, v205
    v_cvt_pk_bf16_f32 v213, v206, v207
    v_cvt_pk_bf16_f32 v214, v208, v209
    v_cvt_pk_bf16_f32 v215, v210, v211
    s_add_u32 s7, s6, 2
    s_cmp_ge_u32 s7, 86
    s_cbranch_scc1 Lskip_47
    buffer_store_dwordx4 v[212:215], v12, s[48:51], s5 offen offset:2048 sc1
Lskip_47:
L_p3_done:
    s_waitcnt lgkmcnt(0)
    s_mov_b32 s88, 0
    buffer_load_dwordx4 v[40:43], v24, s[48:51], 0 offen offset:0 sc1
    buffer_load_dwordx4 v[44:47], v25, s[48:51], 0 offen offset:0 sc1
    buffer_load_dwordx4 v[48:51], v24, s[48:51], 0 offen offset:3072 sc1
    buffer_load_dwordx4 v[52:55], v25, s[48:51], 0 offen offset:3072 sc1
    buffer_load_dwordx4 v[56:59], v24, s[48:51], s16 offen offset:2048 sc1
    buffer_load_dwordx4 v[60:63], v25, s[48:51], s16 offen offset:2048 sc1
    buffer_load_dwordx4 v[64:67], v24, s[48:51], s17 offen offset:1024 sc1
    buffer_load_dwordx4 v[72:75], v25, s[48:51], s17 offen offset:1024 sc1
    buffer_load_dwordx4 v[76:79], v24, s[48:51], s30 offen offset:0 sc1
    buffer_load_dwordx4 v[80:83], v25, s[48:51], s30 offen offset:0 sc1
    buffer_load_dwordx4 v[84:87], v24, s[48:51], s30 offen offset:3072 sc1
    buffer_load_dwordx4 v[88:91], v25, s[48:51], s30 offen offset:3072 sc1
    s_mov_b32 s89, 28672
    buffer_load_dwordx4 a[144:147], v244, s[48:51], s89 offen offset:0 sc1
    buffer_load_dwordx4 a[148:151], v243, s[48:51], s89 offen offset:0 sc1
    s_mov_b32 s89, 32768
    buffer_load_dwordx4 a[152:155], v244, s[48:51], s89 offen offset:2048 sc1
    buffer_load_dwordx4 a[156:159], v243, s[48:51], s89 offen offset:2048 sc1
    s_mov_b32 s89, 40960
    buffer_load_dwordx4 a[160:163], v244, s[48:51], s89 offen offset:0 sc1
    buffer_load_dwordx4 a[164:167], v243, s[48:51], s89 offen offset:0 sc1
    buffer_load_dwordx4 a[168:171], v244, s[48:51], s34 offen offset:0 sc1
    buffer_load_dwordx4 a[172:175], v243, s[48:51], s34 offen offset:0 sc1
    s_waitcnt vmcnt(37)
    v_add_f32_dpp v36, v36, v36 quad_perm:[1,0,3,2] row_mask:0xf bank_mask:0xf
    v_add_f32_dpp v37, v37, v37 quad_perm:[1,0,3,2] row_mask:0xf bank_mask:0xf
    s_waitcnt vmcnt(36)
    v_add_f32_dpp v38, v38, v38 quad_perm:[1,0,3,2] row_mask:0xf bank_mask:0xf
    v_add_f32_dpp v39, v39, v39 quad_perm:[1,0,3,2] row_mask:0xf bank_mask:0xf
    v_add_f32_dpp v36, v36, v36 quad_perm:[2,3,0,1] row_mask:0xf bank_mask:0xf
    v_add_f32_dpp v37, v37, v37 quad_perm:[2,3,0,1] row_mask:0xf bank_mask:0xf
    v_add_f32_dpp v38, v38, v38 quad_perm:[2,3,0,1] row_mask:0xf bank_mask:0xf
    v_add_f32_dpp v39, v39, v39 quad_perm:[2,3,0,1] row_mask:0xf bank_mask:0xf
    v_cvt_pk_bf16_f32 v36, v36, v37
    v_cvt_pk_bf16_f32 v38, v38, v39
    v_and_b32 v37, 0xffff0000, v36
    v_lshlrev_b32 v36, 16, v36
    v_and_b32 v39, 0xffff0000, v38
    v_lshlrev_b32 v38, 16, v38
    v_bfe_u32 v9, v1, 2, 3
    s_lshl_b32 s6, s72, 7
    s_add_u32 s6, s6, 65792
    v_lshl_add_u32 v9, v9, 4, s6
    ds_write_b128 v9, v[36:39]
    v_lshrrev_b32 v9, 5, v1
    v_lshl_add_u32 v9, v9, 4, s6
    ds_read_b128 v[164:167], v9 offset:0
    ds_read_b128 v[168:171], v9 offset:32
    ds_read_b128 v[172:175], v9 offset:64
    ds_read_b128 v[176:179], v9 offset:96
    s_waitcnt vmcnt(19)
    v_max3_u32 v2, v40, v41, v42
    s_waitcnt vmcnt(18)
    v_max3_u32 v2, v2, v43, v44
    v_max3_u32 v2, v2, v45, v46
    v_max_u32 v2, v2, v47
    v_cmp_eq_u32 vcc, -1, v2
    s_cbranch_vccnz Lact_0
Lactb_0:
    v_mfma_f32_32x32x16_bf16 v[100:115], a[0:3], v[40:43], 0
    buffer_load_dwordx4 v[92:95], v24, s[48:51], s31 offen offset:2048 sc1
    v_mfma_f32_32x32x16_bf16 v[116:131], a[0:3], v[44:47], 0
    buffer_load_dwordx4 v[96:99], v25, s[48:51], s31 offen offset:2048 sc1
    v_mfma_f32_32x32x16_bf16 v[132:147], a[4:7], v[40:43], 0
    s_waitcnt vmcnt(19)
    v_max3_u32 v2, v48, v49, v50
    s_waitcnt vmcnt(18)
    v_max3_u32 v2, v2, v51, v52
    v_max3_u32 v2, v2, v53, v54
    v_max_u32 v2, v2, v55
    v_cmp_eq_u32 vcc, -1, v2
    v_mfma_f32_32x32x16_bf16 v[148:163], a[4:7], v[44:47], 0
    s_cbranch_vccnz Lact_1
Lactb_1:
    v_mfma_f32_32x32x16_bf16 v[100:115], a[8:11], v[48:51], v[100:115]
    buffer_load_dwordx4 v[40:43], v24, s[48:51], 0 offen offset:1024 sc1
    v_mfma_f32_32x32x16_bf16 v[116:131], a[8:11], v[52:55], v[116:131]
    buffer_load_dwordx4 v[44:47], v25, s[48:51], 0 offen offset:1024 sc1
    v_mfma_f32_32x32x16_bf16 v[132:147], a[12:15], v[48:51], v[132:147]
    s_waitcnt vmcnt(19)
    v_max3_u32 v2, v56, v57, v58
    s_waitcnt vmcnt(18)
    v_max3_u32 v2, v2, v59, v60
    v_max3_u32 v2, v2, v61, v62
    v_max_u32 v2, v2, v63
    v_cmp_eq_u32 vcc, -1, v2
    v_mfma_f32_32x32x16_bf16 v[148:163], a[12:15], v[52:55], v[148:163]
    s_cbranch_vccnz Lact_2
Lactb_2:
    v_mfma_f32_32x32x16_bf16 v[100:115], a[16:19], v[56:59], v[100:115]
    buffer_load_dwordx4 v[48:51], v24, s[48:51], s16 offen offset:0 sc1
    v_mfma_f32_32x32x16_bf16 v[116:131], a[16:19], v[60:63], v[116:131]
    buffer_load_dwordx4 v[52:55], v25, s[48:51], s16 offen offset:0 sc1
    v_mfma_f32_32x32x16_bf16 v[132:147], a[20:23], v[56:59], v[132:147]
    s_waitcnt vmcnt(19)
    v_max3_u32 v2, v64, v65, v66
    s_waitcnt vmcnt(18)
    v_max3_u32 v2, v2, v67, v72
    v_max3_u32 v2, v2, v73, v74
    v_max_u32 v2, v2, v75
    v_cmp_eq_u32 vcc, -1, v2
    v_mfma_f32_32x32x16_bf16 v[148:163], a[20:23], v[60:63], v[148:163]
    s_cbranch_vccnz Lact_3
Lactb_3:
    v_mfma_f32_32x32x16_bf16 v[100:115], a[24:27], v[64:67], v[100:115]
    buffer_load_dwordx4 v[56:59], v24, s[48:51], s16 offen offset:3072 sc1
    v_mfma_f32_32x32x16_bf16 v[116:131], a[24:27], v[72:75], v[116:131]
    buffer_load_dwordx4 v[60:63], v25, s[48:51], s16 offen offset:3072 sc1
    v_mfma_f32_32x32x16_bf16 v[132:147], a[28:31], v[64:67], v[132:147]
    s_waitcnt vmcnt(19)
    v_max3_u32 v2, v76, v77, v78
    s_waitcnt vmcnt(18)
    v_max3_u32 v2, v2, v79, v80
    v_max3_u32 v2, v2, v81, v82
    v_max_u32 v2, v2, v83
    v_cmp_eq_u32 vcc, -1, v2
    v_mfma_f32_32x32x16_bf16 v[148:163], a[28:31], v[72:75], v[148:163]
    s_cbranch_vccnz Lact_4
Lactb_4:
    v_mfma_f32_32x32x16_bf16 v[100:115], a[32:35], v[76:79], v[100:115]
    buffer_load_dwordx4 v[64:67], v24, s[48:51], s17 offen offset:2048 sc1
    v_mfma_f32_32x32x16_bf16 v[116:131], a[32:35], v[80:83], v[116:131]
    buffer_load_dwordx4 v[72:75], v25, s[48:51], s17 offen offset:2048 sc1
    v_mfma_f32_32x32x16_bf16 v[132:147], a[36:39], v[76:79], v[132:147]
    s_waitcnt vmcnt(19)
    v_max3_u32 v2, v84, v85, v86
    s_waitcnt vmcnt(18)
    v_max3_u32 v2, v2, v87, v88
    v_max3_u32 v2, v2, v89, v90
    v_max_u32 v2, v2, v91
    v_cmp_eq_u32 vcc, -1, v2
    v_mfma_f32_32x32x16_bf16 v[148:163], a[36:39], v[80:83], v[148:163]
    s_cbranch_vccnz Lact_5
Lactb_5:
    v_mfma_f32_32x32x16_bf16 v[100:115], a[40:43], v[84:87], v[100:115]
    buffer_load_dwordx4 v[76:79], v24, s[48:51], s30 offen offset:1024 sc1
    v_mfma_f32_32x32x16_bf16 v[116:131], a[40:43], v[88:91], v[116:131]
    buffer_load_dwordx4 v[80:83], v25, s[48:51], s30 offen offset:1024 sc1
    v_mfma_f32_32x32x16_bf16 v[132:147], a[44:47], v[84:87], v[132:147]
    s_waitcnt vmcnt(11)
    v_max3_u32 v2, v92, v93, v94
    s_waitcnt vmcnt(10)
    v_max3_u32 v2, v2, v95, v96
    v_max3_u32 v2, v2, v97, v98
    v_max_u32 v2, v2, v99
    v_cmp_eq_u32 vcc, -1, v2
    v_mfma_f32_32x32x16_bf16 v[148:163], a[44:47], v[88:91], v[148:163]
    s_cbranch_vccnz Lact_6
Lactb_6:
    v_mfma_f32_32x32x16_bf16 v[100:115], a[48:51], v[92:95], v[100:115]
    buffer_load_dwordx4 v[84:87], v24, s[48:51], s31 offen offset:0 sc1
    v_mfma_f32_32x32x16_bf16 v[116:131], a[48:51], v[96:99], v[116:131]
    buffer_load_dwordx4 v[88:91], v25, s[48:51], s31 offen offset:0 sc1
    v_mfma_f32_32x32x16_bf16 v[132:147], a[52:55], v[92:95], v[132:147]
    s_waitcnt vmcnt(11)
    v_max3_u32 v2, v40, v41, v42
    s_waitcnt vmcnt(10)
    v_max3_u32 v2, v2, v43, v44
    v_max3_u32 v2, v2, v45, v46
    v_max_u32 v2, v2, v47
    v_cmp_eq_u32 vcc, -1, v2
    v_mfma_f32_32x32x16_bf16 v[148:163], a[52:55], v[96:99], v[148:163]
    s_cbranch_vccnz Lact_7
Lactb_7:
    v_mfma_f32_32x32x16_bf16 v[100:115], a[56:59], v[40:43], v[100:115]
    buffer_load_dwordx4 v[92:95], v24, s[48:51], s31 offen offset:3072 sc1
    v_mfma_f32_32x32x16_bf16 v[116:131], a[56:59], v[44:47], v[116:131]
    buffer_load_dwordx4 v[96:99], v25, s[48:51], s31 offen offset:3072 sc1
    v_mfma_f32_32x32x16_bf16 v[132:147], a[60:63], v[40:43], v[132:147]
    s_waitcnt vmcnt(11)
    v_max3_u32 v2, v48, v49, v50
    s_waitcnt vmcnt(10)
    v_max3_u32 v2, v2, v51, v52
    v_max3_u32 v2, v2, v53, v54
    v_max_u32 v2, v2, v55
    v_cmp_eq_u32 vcc, -1, v2
    v_mfma_f32_32x32x16_bf16 v[148:163], a[60:63], v[44:47], v[148:163]
    s_cbranch_vccnz Lact_8
Lactb_8:
    v_mfma_f32_32x32x16_bf16 v[100:115], a[64:67], v[48:51], v[100:115]
    buffer_load_dwordx4 v[40:43], v24, s[48:51], 0 offen offset:2048 sc1
    v_mfma_f32_32x32x16_bf16 v[116:131], a[64:67], v[52:55], v[116:131]
    buffer_load_dwordx4 v[44:47], v25, s[48:51], 0 offen offset:2048 sc1
    v_mfma_f32_32x32x16_bf16 v[132:147], a[68:71], v[48:51], v[132:147]
    s_waitcnt vmcnt(11)
    v_max3_u32 v2, v56, v57, v58
    s_waitcnt vmcnt(10)
    v_max3_u32 v2, v2, v59, v60
    v_max3_u32 v2, v2, v61, v62
    v_max_u32 v2, v2, v63
    v_cmp_eq_u32 vcc, -1, v2
    v_mfma_f32_32x32x16_bf16 v[148:163], a[68:71], v[52:55], v[148:163]
    s_cbranch_vccnz Lact_9
Lactb_9:
    v_mfma_f32_32x32x16_bf16 v[100:115], a[72:75], v[56:59], v[100:115]
    buffer_load_dwordx4 v[48:51], v24, s[48:51], s16 offen offset:1024 sc1
    v_mfma_f32_32x32x16_bf16 v[116:131], a[72:75], v[60:63], v[116:131]
    buffer_load_dwordx4 v[52:55], v25, s[48:51], s16 offen offset:1024 sc1
    v_mfma_f32_32x32x16_bf16 v[132:147], a[76:79], v[56:59], v[132:147]
    s_waitcnt vmcnt(11)
    v_max3_u32 v2, v64, v65, v66
    s_waitcnt vmcnt(10)
    v_max3_u32 v2, v2, v67, v72
    v_max3_u32 v2, v2, v73, v74
    v_max_u32 v2, v2, v75
    v_cmp_eq_u32 vcc, -1, v2
    v_mfma_f32_32x32x16_bf16 v[148:163], a[76:79], v[60:63], v[148:163]
    s_cbranch_vccnz Lact_10
Lactb_10:
    v_mfma_f32_32x32x16_bf16 v[100:115], a[80:83], v[64:67], v[100:115]
    buffer_load_dwordx4 v[56:59], v24, s[48:51], s17 offen offset:0 sc1
    v_mfma_f32_32x32x16_bf16 v[116:131], a[80:83], v[72:75], v[116:131]
    buffer_load_dwordx4 v[60:63], v25, s[48:51], s17 offen offset:0 sc1
    v_mfma_f32_32x32x16_bf16 v[132:147], a[84:87], v[64:67], v[132:147]
    s_waitcnt vmcnt(11)
    v_max3_u32 v2, v76, v77, v78
    s_waitcnt vmcnt(10)
    v_max3_u32 v2, v2, v79, v80
    v_max3_u32 v2, v2, v81, v82
    v_max_u32 v2, v2, v83
    v_cmp_eq_u32 vcc, -1, v2
    v_mfma_f32_32x32x16_bf16 v[148:163], a[84:87], v[72:75], v[148:163]
    s_cbranch_vccnz Lact_11
Lactb_11:
    v_mfma_f32_32x32x16_bf16 v[100:115], a[88:91], v[76:79], v[100:115]
    buffer_load_dwordx4 v[64:67], v24, s[48:51], s17 offen offset:3072 sc1
    v_mfma_f32_32x32x16_bf16 v[116:131], a[88:91], v[80:83], v[116:131]
    buffer_load_dwordx4 v[72:75], v25, s[48:51], s17 offen offset:3072 sc1
    v_mfma_f32_32x32x16_bf16 v[132:147], a[92:95], v[76:79], v[132:147]
    s_waitcnt vmcnt(11)
    v_max3_u32 v2, v84, v85, v86
    s_waitcnt vmcnt(10)
    v_max3_u32 v2, v2, v87, v88
    v_max3_u32 v2, v2, v89, v90
    v_max_u32 v2, v2, v91
    v_cmp_eq_u32 vcc, -1, v2
    v_mfma_f32_32x32x16_bf16 v[148:163], a[92:95], v[80:83], v[148:163]
    s_cbranch_vccnz Lact_12
Lactb_12:
    v_mfma_f32_32x32x16_bf16 v[100:115], a[96:99], v[84:87], v[100:115]
    buffer_load_dwordx4 v[76:79], v24, s[48:51], s30 offen offset:2048 sc1
    v_mfma_f32_32x32x16_bf16 v[116:131], a[96:99], v[88:91], v[116:131]
    buffer_load_dwordx4 v[80:83], v25, s[48:51], s30 offen offset:2048 sc1
    v_mfma_f32_32x32x16_bf16 v[132:147], a[100:103], v[84:87], v[132:147]
    s_waitcnt vmcnt(11)
    v_max3_u32 v2, v92, v93, v94
    s_waitcnt vmcnt(10)
    v_max3_u32 v2, v2, v95, v96
    v_max3_u32 v2, v2, v97, v98
    v_max_u32 v2, v2, v99
    v_cmp_eq_u32 vcc, -1, v2
    v_mfma_f32_32x32x16_bf16 v[148:163], a[100:103], v[88:91], v[148:163]
    s_cbranch_vccnz Lact_13
Lactb_13:
    v_mfma_f32_32x32x16_bf16 v[100:115], a[104:107], v[92:95], v[100:115]
    buffer_load_dwordx4 v[84:87], v24, s[48:51], s31 offen offset:1024 sc1
    v_mfma_f32_32x32x16_bf16 v[116:131], a[104:107], v[96:99], v[116:131]
    buffer_load_dwordx4 v[88:91], v25, s[48:51], s31 offen offset:1024 sc1
    v_mfma_f32_32x32x16_bf16 v[132:147], a[108:111], v[92:95], v[132:147]
    s_waitcnt vmcnt(11)
    v_max3_u32 v2, v40, v41, v42
    s_waitcnt vmcnt(10)
    v_max3_u32 v2, v2, v43, v44
    v_max3_u32 v2, v2, v45, v46
    v_max_u32 v2, v2, v47
    v_cmp_eq_u32 vcc, -1, v2
    v_mfma_f32_32x32x16_bf16 v[148:163], a[108:111], v[96:99], v[148:163]
    s_cbranch_vccnz Lact_14
Lactb_14:
    v_mfma_f32_32x32x16_bf16 v[100:115], a[112:115], v[40:43], v[100:115]
    buffer_load_dwordx4 v[92:95], v24, s[48:51], s32 offen offset:0 sc1
    v_mfma_f32_32x32x16_bf16 v[116:131], a[112:115], v[44:47], v[116:131]
    buffer_load_dwordx4 v[96:99], v25, s[48:51], s32 offen offset:0 sc1
    v_mfma_f32_32x32x16_bf16 v[132:147], a[116:119], v[40:43], v[132:147]
    s_waitcnt vmcnt(11)
    v_max3_u32 v2, v48, v49, v50
    s_waitcnt vmcnt(10)
    v_max3_u32 v2, v2, v51, v52
    v_max3_u32 v2, v2, v53, v54
    v_max_u32 v2, v2, v55
    v_cmp_eq_u32 vcc, -1, v2
    v_mfma_f32_32x32x16_bf16 v[148:163], a[116:119], v[44:47], v[148:163]
    s_cbranch_vccnz Lact_15
Lactb_15:
    v_mfma_f32_32x32x16_bf16 v[100:115], a[120:123], v[48:51], v[100:115]
    buffer_load_dwordx4 v[40:43], v26, s[48:51], 0 offen sc1
    v_mfma_f32_32x32x16_bf16 v[116:131], a[120:123], v[52:55], v[116:131]
    buffer_load_dwordx4 v[44:47], v27, s[48:51], 0 offen sc1
    v_mfma_f32_32x32x16_bf16 v[132:147], a[124:127], v[48:51], v[132:147]
    s_waitcnt vmcnt(11)
    v_max3_u32 v2, v56, v57, v58
    s_waitcnt vmcnt(10)
    v_max3_u32 v2, v2, v59, v60
    v_max3_u32 v2, v2, v61, v62
    v_max_u32 v2, v2, v63
    v_cmp_eq_u32 vcc, -1, v2
    v_mfma_f32_32x32x16_bf16 v[148:163], a[124:127], v[52:55], v[148:163]
    s_cbranch_vccnz Lact_16
Lactb_16:
    v_mfma_f32_32x32x16_bf16 v[100:115], a[128:131], v[56:59], v[100:115]
    v_mfma_f32_32x32x16_bf16 v[116:131], a[128:131], v[60:63], v[116:131]
    v_mfma_f32_32x32x16_bf16 v[132:147], a[132:135], v[56:59], v[132:147]
    s_waitcnt vmcnt(9)
    v_max3_u32 v2, v64, v65, v66
    s_waitcnt vmcnt(8)
    v_max3_u32 v2, v2, v67, v72
    v_max3_u32 v2, v2, v73, v74
    v_max_u32 v2, v2, v75
    v_cmp_eq_u32 vcc, -1, v2
    v_mfma_f32_32x32x16_bf16 v[148:163], a[132:135], v[60:63], v[148:163]
    s_cbranch_vccnz Lact_17
Lactb_17:
    v_mfma_f32_32x32x16_bf16 v[100:115], a[136:139], v[64:67], v[100:115]
    v_mfma_f32_32x32x16_bf16 v[116:131], a[136:139], v[72:75], v[116:131]
    v_mfma_f32_32x32x16_bf16 v[132:147], a[140:143], v[64:67], v[132:147]
    s_waitcnt vmcnt(7)
    v_max3_u32 v2, v76, v77, v78
    s_waitcnt vmcnt(6)
    v_max3_u32 v2, v2, v79, v80
    v_max3_u32 v2, v2, v81, v82
    v_max_u32 v2, v2, v83
    v_cmp_eq_u32 vcc, -1, v2
    v_mfma_f32_32x32x16_bf16 v[148:163], a[140:143], v[72:75], v[148:163]
    s_cbranch_vccnz Lact_18
Lactb_18:
    v_mfma_f32_32x32x16_bf16 v[100:115], a[144:147], v[76:79], v[100:115]
    v_mfma_f32_32x32x16_bf16 v[116:131], a[144:147], v[80:83], v[116:131]
    v_mfma_f32_32x32x16_bf16 v[132:147], a[148:151], v[76:79], v[132:147]
    s_waitcnt vmcnt(5)
    v_max3_u32 v2, v84, v85, v86
    s_waitcnt vmcnt(4)
    v_max3_u32 v2, v2, v87, v88
    v_max3_u32 v2, v2, v89, v90
    v_max_u32 v2, v2, v91
    v_cmp_eq_u32 vcc, -1, v2
    v_mfma_f32_32x32x16_bf16 v[148:163], a[148:151], v[80:83], v[148:163]
    s_cbranch_vccnz Lact_19
Lactb_19:
    v_mfma_f32_32x32x16_bf16 v[100:115], a[152:155], v[84:87], v[100:115]
    v_mfma_f32_32x32x16_bf16 v[116:131], a[152:155], v[88:91], v[116:131]
    v_mfma_f32_32x32x16_bf16 v[132:147], a[156:159], v[84:87], v[132:147]
    s_waitcnt vmcnt(3)
    v_max3_u32 v2, v92, v93, v94
    s_waitcnt vmcnt(2)
    v_max3_u32 v2, v2, v95, v96
    v_max3_u32 v2, v2, v97, v98
    v_max_u32 v2, v2, v99
    v_cmp_eq_u32 vcc, -1, v2
    v_mfma_f32_32x32x16_bf16 v[148:163], a[156:159], v[88:91], v[148:163]
    s_cbranch_vccnz Lact_20
Lactb_20:
    v_mfma_f32_32x32x16_bf16 v[100:115], a[160:163], v[92:95], v[100:115]
    v_mfma_f32_32x32x16_bf16 v[116:131], a[160:163], v[96:99], v[116:131]
    v_mfma_f32_32x32x16_bf16 v[132:147], a[164:167], v[92:95], v[132:147]
    s_waitcnt vmcnt(1)
    v_max3_u32 v2, v40, v41, v42
    s_waitcnt vmcnt(0)
    v_max3_u32 v2, v2, v43, v44
    v_max3_u32 v2, v2, v45, v46
    v_max_u32 v2, v2, v47
    v_cmp_eq_u32 vcc, -1, v2
    v_mfma_f32_32x32x16_bf16 v[148:163], a[164:167], v[96:99], v[148:163]
    s_cbranch_vccnz Lact_21
Lactb_21:
    s_cmp_ge_u32 s72, 2
    s_cbranch_scc1 Lskip_48
    v_mfma_f32_32x32x16_bf16 v[100:115], a[168:171], v[40:43], v[100:115]
    v_mfma_f32_32x32x16_bf16 v[116:131], a[168:171], v[44:47], v[116:131]
    v_mfma_f32_32x32x16_bf16 v[132:147], a[172:175], v[40:43], v[132:147]
    v_mfma_f32_32x32x16_bf16 v[148:163], a[172:175], v[44:47], v[148:163]
Lskip_48:
    s_nop 11
    ds_write_b128 v30, v[116:119] offset:0
    ds_write_b128 v30, v[120:123] offset:1024
    ds_write_b128 v30, v[124:127] offset:2048
    ds_write_b128 v30, v[128:131] offset:3072
    ds_write_b128 v31, v[132:135] offset:0
    ds_write_b128 v31, v[136:139] offset:1024
    ds_write_b128 v31, v[140:143] offset:2048
    ds_write_b128 v31, v[144:147] offset:3072
    ds_write_b128 v32, v[148:151] offset:0
    ds_write_b128 v32, v[152:155] offset:1024
    ds_write_b128 v32, v[156:159] offset:2048
    ds_write_b128 v32, v[160:163] offset:3072
    ds_read_b64_tr_b16 v[12:13], v28 offset:0
    ds_read_b64_tr_b16 v[14:15], v28 offset:512
    ds_read_b64_tr_b16 v[16:17], v28 offset:1024
    ds_read_b64_tr_b16 v[18:19], v28 offset:1536
    s_waitcnt lgkmcnt(0)
    s_barrier
    ds_read_b128 v[180:183], v33 offset:0
    ds_read_b128 v[184:187], v33 offset:1024
    ds_read_b128 v[188:191], v33 offset:2048
    ds_read_b128 v[192:195], v33 offset:3072
    ds_read_b128 v[196:199], v33 offset:4096
    ds_read_b128 v[200:203], v33 offset:5120
    ds_read_b128 v[204:207], v33 offset:6144
    ds_read_b128 v[208:211], v33 offset:7168
    ds_read_b128 v[212:215], v33 offset:8192
    ds_read_b128 v[216:219], v33 offset:9216
    ds_read_b128 v[220:223], v33 offset:10240
    ds_read_b128 v[224:227], v33 offset:11264
    v_lshlrev_b32 v36, 16, v12
    v_and_b32 v37, 0xffff0000, v12
    v_lshlrev_b32 v38, 16, v13
    v_and_b32 v39, 0xffff0000, v13
    v_lshlrev_b32 v40, 16, v14
    v_and_b32 v41, 0xffff0000, v14
    v_lshlrev_b32 v42, 16, v15
    v_and_b32 v43, 0xffff0000, v15
    v_lshlrev_b32 v44, 16, v16
    v_and_b32 v45, 0xffff0000, v16
    v_lshlrev_b32 v46, 16, v17
    v_and_b32 v47, 0xffff0000, v17
    v_lshlrev_b32 v48, 16, v18
    v_and_b32 v49, 0xffff0000, v18
    v_lshlrev_b32 v50, 16, v19
    v_and_b32 v51, 0xffff0000, v19
    s_waitcnt lgkmcnt(11)
    v_pk_add_f32 v[100:101], v[100:101], v[180:181]
    v_pk_add_f32 v[102:103], v[102:103], v[182:183]
    s_waitcnt lgkmcnt(10)
    v_pk_add_f32 v[104:105], v[104:105], v[184:185]
    v_pk_add_f32 v[106:107], v[106:107], v[186:187]
    s_waitcnt lgkmcnt(9)
    v_pk_add_f32 v[108:109], v[108:109], v[188:189]
    v_pk_add_f32 v[110:111], v[110:111], v[190:191]
    s_waitcnt lgkmcnt(8)
    v_pk_add_f32 v[112:113], v[112:113], v[192:193]
    v_pk_add_f32 v[114:115], v[114:115], v[194:195]
    s_waitcnt lgkmcnt(7)
    v_pk_add_f32 v[100:101], v[100:101], v[196:197]
    v_pk_add_f32 v[102:103], v[102:103], v[198:199]
    s_waitcnt lgkmcnt(6)
    v_pk_add_f32 v[104:105], v[104:105], v[200:201]
    v_pk_add_f32 v[106:107], v[106:107], v[202:203]
    s_waitcnt lgkmcnt(5)
    v_pk_add_f32 v[108:109], v[108:109], v[204:205]
    v_pk_add_f32 v[110:111], v[110:111], v[206:207]
    s_waitcnt lgkmcnt(4)
    v_pk_add_f32 v[112:113], v[112:113], v[208:209]
    v_pk_add_f32 v[114:115], v[114:115], v[210:211]
    s_waitcnt lgkmcnt(3)
    v_pk_add_f32 v[100:101], v[100:101], v[212:213]
    v_pk_add_f32 v[102:103], v[102:103], v[214:215]
    s_waitcnt lgkmcnt(2)
    v_pk_add_f32 v[104:105], v[104:105], v[216:217]
    v_pk_add_f32 v[106:107], v[106:107], v[218:219]
    s_waitcnt lgkmcnt(1)
    v_pk_add_f32 v[108:109], v[108:109], v[220:221]
    v_pk_add_f32 v[110:111], v[110:111], v[222:223]
    s_waitcnt lgkmcnt(0)
    v_pk_add_f32 v[112:113], v[112:113], v[224:225]
    v_pk_add_f32 v[114:115], v[114:115], v[226:227]
    v_pk_fma_f32 v[36:37], v[100:101], v[164:165], v[36:37]
    v_pk_fma_f32 v[38:39], v[102:103], v[166:167], v[38:39]
    v_pk_fma_f32 v[40:41], v[104:105], v[168:169], v[40:41]
    v_pk_fma_f32 v[42:43], v[106:107], v[170:171], v[42:43]
    v_pk_fma_f32 v[44:45], v[108:109], v[172:173], v[44:45]
    v_pk_fma_f32 v[46:47], v[110:111], v[174:175], v[46:47]
    v_pk_fma_f32 v[48:49], v[112:113], v[176:177], v[48:49]
    v_pk_fma_f32 v[50:51], v[114:115], v[178:179], v[50:51]
    v_cvt_pk_bf16_f32 v52, v36, v37
    v_cvt_pk_bf16_f32 v53, v38, v39
    v_cvt_pk_bf16_f32 v54, v40, v41
    v_cvt_pk_bf16_f32 v55, v42, v43
    v_cvt_pk_bf16_f32 v56, v44, v45
    v_cvt_pk_bf16_f32 v57, v46, v47
    v_cvt_pk_bf16_f32 v58, v48, v49
    v_cvt_pk_bf16_f32 v59, v50, v51
    v_permlane32_swap_b32 v52, v54
    v_permlane32_swap_b32 v53, v55
    v_permlane32_swap_b32 v56, v58
    v_permlane32_swap_b32 v57, v59
    buffer_store_dwordx4 v[52:55], v29, s[64:67], s33 offen offset:0
    buffer_store_dwordx4 v[56:59], v29, s[64:67], s33 offen offset:32
    s_waitcnt vmcnt(0) lgkmcnt(0)
L_end:
    s_endpgm
Lmod_again:
    s_add_u32 s88, s88, 1
    s_cmp_gt_u32 s88, 0x8000
    s_cbranch_scc1 Lmod_back
    buffer_load_dwordx4 v[12:15], v247, s[48:51], 0 offen sc1
    buffer_load_dwordx4 v[88:91], v245, s[48:51], 0 offen sc1
    buffer_load_dwordx4 v[92:95], v245, s[48:51], 0 offen offset:16 sc1
    s_waitcnt vmcnt(0)
    v_xor_b32 v8, s100, v14
    v_xor_b32 v9, s100, v90
    v_xor_b32 v10, s100, v94
    v_or3_b32 v8, v8, v9, v10
    v_cmp_ne_u32 vcc, 0, v8
    s_nop 1
    s_cbranch_vccnz Lmod_again
    s_branch Lmod_back
L_nogemm:
    s_branch L_p3_done
Lact_0:
    s_add_u32 s88, s88, 1
    s_cmp_gt_u32 s88, 32768
    s_cbranch_scc1 Lactb_0
    buffer_load_dwordx4 v[40:43], v24, s[48:51], 0 offen offset:0 sc1
    buffer_load_dwordx4 v[44:47], v25, s[48:51], 0 offen offset:0 sc1
    buffer_load_dwordx4 v[48:51], v24, s[48:51], 0 offen offset:3072 sc1
    buffer_load_dwordx4 v[52:55], v25, s[48:51], 0 offen offset:3072 sc1
    buffer_load_dwordx4 v[56:59], v24, s[48:51], s16 offen offset:2048 sc1
    buffer_load_dwordx4 v[60:63], v25, s[48:51], s16 offen offset:2048 sc1
    buffer_load_dwordx4 v[64:67], v24, s[48:51], s17 offen offset:1024 sc1
    buffer_load_dwordx4 v[72:75], v25, s[48:51], s17 offen offset:1024 sc1
    buffer_load_dwordx4 v[76:79], v24, s[48:51], s30 offen offset:0 sc1
    buffer_load_dwordx4 v[80:83], v25, s[48:51], s30 offen offset:0 sc1
    buffer_load_dwordx4 v[84:87], v24, s[48:51], s30 offen offset:3072 sc1
    buffer_load_dwordx4 v[88:91], v25, s[48:51], s30 offen offset:3072 sc1
    s_waitcnt vmcnt(10)
    v_max3_u32 v2, v40, v41, v42
    v_max3_u32 v2, v2, v43, v44
    v_max3_u32 v2, v2, v45, v46
    v_max_u32 v2, v2, v47
    v_cmp_eq_u32 vcc, -1, v2
    s_cbranch_vccnz Lact_0
    s_branch Lactb_0
Lact_1:
    s_add_u32 s88, s88, 1
    s_cmp_gt_u32 s88, 32768
    s_cbranch_scc1 Lactb_1
    buffer_load_dwordx4 v[48:51], v24, s[48:51], 0 offen offset:3072 sc1
    buffer_load_dwordx4 v[52:55], v25, s[48:51], 0 offen offset:3072 sc1
    buffer_load_dwordx4 v[56:59], v24, s[48:51], s16 offen offset:2048 sc1
    buffer_load_dwordx4 v[60:63], v25, s[48:51], s16 offen offset:2048 sc1
    buffer_load_dwordx4 v[64:67], v24, s[48:51], s17 offen offset:1024 sc1
    buffer_load_dwordx4 v[72:75], v25, s[48:51], s17 offen offset:1024 sc1
    buffer_load_dwordx4 v[76:79], v24, s[48:51], s30 offen offset:0 sc1
    buffer_load_dwordx4 v[80:83], v25, s[48:51], s30 offen offset:0 sc1
    buffer_load_dwordx4 v[84:87], v24, s[48:51], s30 offen offset:3072 sc1
    buffer_load_dwordx4 v[88:91], v25, s[48:51], s30 offen offset:3072 sc1
    buffer_load_dwordx4 v[92:95], v24, s[48:51], s31 offen offset:2048 sc1
    buffer_load_dwordx4 v[96:99], v25, s[48:51], s31 offen offset:2048 sc1
    s_waitcnt vmcnt(10)
    v_max3_u32 v2, v48, v49, v50
    v_max3_u32 v2, v2, v51, v52
    v_max3_u32 v2, v2, v53, v54
    v_max_u32 v2, v2, v55
    v_cmp_eq_u32 vcc, -1, v2
    s_cbranch_vccnz Lact_1
    s_branch Lactb_1
Lact_2:
    s_add_u32 s88, s88, 1
    s_cmp_gt_u32 s88, 32768
    s_cbranch_scc1 Lactb_2
    buffer_load_dwordx4 v[56:59], v24, s[48:51], s16 offen offset:2048 sc1
    buffer_load_dwordx4 v[60:63], v25, s[48:51], s16 offen offset:2048 sc1
    buffer_load_dwordx4 v[64:67], v24, s[48:51], s17 offen offset:1024 sc1
    buffer_load_dwordx4 v[72:75], v25, s[48:51], s17 offen offset:1024 sc1
    buffer_load_dwordx4 v[76:79], v24, s[48:51], s30 offen offset:0 sc1
    buffer_load_dwordx4 v[80:83], v25, s[48:51], s30 offen offset:0 sc1
    buffer_load_dwordx4 v[84:87], v24, s[48:51], s30 offen offset:3072 sc1
    buffer_load_dwordx4 v[88:91], v25, s[48:51], s30 offen offset:3072 sc1
    buffer_load_dwordx4 v[92:95], v24, s[48:51], s31 offen offset:2048 sc1
    buffer_load_dwordx4 v[96:99], v25, s[48:51], s31 offen offset:2048 sc1
    buffer_load_dwordx4 v[40:43], v24, s[48:51], 0 offen offset:1024 sc1
    buffer_load_dwordx4 v[44:47], v25, s[48:51], 0 offen offset:1024 sc1
    s_waitcnt vmcnt(10)
    v_max3_u32 v2, v56, v57, v58
    v_max3_u32 v2, v2, v59, v60
    v_max3_u32 v2, v2, v61, v62
    v_max_u32 v2, v2, v63
    v_cmp_eq_u32 vcc, -1, v2
    s_cbranch_vccnz Lact_2
    s_branch Lactb_2
Lact_3:
    s_add_u32 s88, s88, 1
    s_cmp_gt_u32 s88, 32768
    s_cbranch_scc1 Lactb_3
    buffer_load_dwordx4 v[64:67], v24, s[48:51], s17 offen offset:1024 sc1
    buffer_load_dwordx4 v[72:75], v25, s[48:51], s17 offen offset:1024 sc1
    buffer_load_dwordx4 v[76:79], v24, s[48:51], s30 offen offset:0 sc1
    buffer_load_dwordx4 v[80:83], v25, s[48:51], s30 offen offset:0 sc1
    buffer_load_dwordx4 v[84:87], v24, s[48:51], s30 offen offset:3072 sc1
    buffer_load_dwordx4 v[88:91], v25, s[48:51], s30 offen offset:3072 sc1
    buffer_load_dwordx4 v[92:95], v24, s[48:51], s31 offen offset:2048 sc1
    buffer_load_dwordx4 v[96:99], v25, s[48:51], s31 offen offset:2048 sc1
    buffer_load_dwordx4 v[40:43], v24, s[48:51], 0 offen offset:1024 sc1
    buffer_load_dwordx4 v[44:47], v25, s[48:51], 0 offen offset:1024 sc1
    buffer_load_dwordx4 v[48:51], v24, s[48:51], s16 offen offset:0 sc1
    buffer_load_dwordx4 v[52:55], v25, s[48:51], s16 offen offset:0 sc1
    s_waitcnt vmcnt(10)
    v_max3_u32 v2, v64, v65, v66
    v_max3_u32 v2, v2, v67, v72
    v_max3_u32 v2, v2, v73, v74
    v_max_u32 v2, v2, v75
    v_cmp_eq_u32 vcc, -1, v2
    s_cbranch_vccnz Lact_3
    s_branch Lactb_3
Lact_4:
    s_add_u32 s88, s88, 1
    s_cmp_gt_u32 s88, 32768
    s_cbranch_scc1 Lactb_4
    buffer_load_dwordx4 v[76:79], v24, s[48:51], s30 offen offset:0 sc1
    buffer_load_dwordx4 v[80:83], v25, s[48:51], s30 offen offset:0 sc1
    buffer_load_dwordx4 v[84:87], v24, s[48:51], s30 offen offset:3072 sc1
    buffer_load_dwordx4 v[88:91], v25, s[48:51], s30 offen offset:3072 sc1
    buffer_load_dwordx4 v[92:95], v24, s[48:51], s31 offen offset:2048 sc1
    buffer_load_dwordx4 v[96:99], v25, s[48:51], s31 offen offset:2048 sc1
    buffer_load_dwordx4 v[40:43], v24, s[48:51], 0 offen offset:1024 sc1
    buffer_load_dwordx4 v[44:47], v25, s[48:51], 0 offen offset:1024 sc1
    buffer_load_dwordx4 v[48:51], v24, s[48:51], s16 offen offset:0 sc1
    buffer_load_dwordx4 v[52:55], v25, s[48:51], s16 offen offset:0 sc1
    buffer_load_dwordx4 v[56:59], v24, s[48:51], s16 offen offset:3072 sc1
    buffer_load_dwordx4 v[60:63], v25, s[48:51], s16 offen offset:3072 sc1
    s_waitcnt vmcnt(10)
    v_max3_u32 v2, v76, v77, v78
    v_max3_u32 v2, v2, v79, v80
    v_max3_u32 v2, v2, v81, v82
    v_max_u32 v2, v2, v83
    v_cmp_eq_u32 vcc, -1, v2
    s_cbranch_vccnz Lact_4
    s_branch Lactb_4
Lact_5:
    s_add_u32 s88, s88, 1
    s_cmp_gt_u32 s88, 32768
    s_cbranch_scc1 Lactb_5
    buffer_load_dwordx4 v[84:87], v24, s[48:51], s30 offen offset:3072 sc1
    buffer_load_dwordx4 v[88:91], v25, s[48:51], s30 offen offset:3072 sc1
    buffer_load_dwordx4 v[92:95], v24, s[48:51], s31 offen offset:2048 sc1
    buffer_load_dwordx4 v[96:99], v25, s[48:51], s31 offen offset:2048 sc1
    buffer_load_dwordx4 v[40:43], v24, s[48:51], 0 offen offset:1024 sc1
    buffer_load_dwordx4 v[44:47], v25, s[48:51], 0 offen offset:1024 sc1
    buffer_load_dwordx4 v[48:51], v24, s[48:51], s16 offen offset:0 sc1
    buffer_load_dwordx4 v[52:55], v25, s[48:51], s16 offen offset:0 sc1
    buffer_load_dwordx4 v[56:59], v24, s[48:51], s16 offen offset:3072 sc1
    buffer_load_dwordx4 v[60:63], v25, s[48:51], s16 offen offset:3072 sc1
    buffer_load_dwordx4 v[64:67], v24, s[48:51], s17 offen offset:2048 sc1
    buffer_load_dwordx4 v[72:75], v25, s[48:51], s17 offen offset:2048 sc1
    s_waitcnt vmcnt(10)
    v_max3_u32 v2, v84, v85, v86
    v_max3_u32 v2, v2, v87, v88
    v_max3_u32 v2, v2, v89, v90
    v_max_u32 v2, v2, v91
    v_cmp_eq_u32 vcc, -1, v2
    s_cbranch_vccnz Lact_5
    s_branch Lactb_5
Lact_6:
    s_add_u32 s88, s88, 1
    s_cmp_gt_u32 s88, 32768
    s_cbranch_scc1 Lactb_6
    buffer_load_dwordx4 v[92:95], v24, s[48:51], s31 offen offset:2048 sc1
    buffer_load_dwordx4 v[96:99], v25, s[48:51], s31 offen offset:2048 sc1
    buffer_load_dwordx4 v[40:43], v24, s[48:51], 0 offen offset:1024 sc1
    buffer_load_dwordx4 v[44:47], v25, s[48:51], 0 offen offset:1024 sc1
    buffer_load_dwordx4 v[48:51], v24, s[48:51], s16 offen offset:0 sc1
    buffer_load_dwordx4 v[52:55], v25, s[48:51], s16 offen offset:0 sc1
    buffer_load_dwordx4 v[56:59], v24, s[48:51], s16 offen offset:3072 sc1
    buffer_load_dwordx4 v[60:63], v25, s[48:51], s16 offen offset:3072 sc1
    buffer_load_dwordx4 v[64:67], v24, s[48:51], s17 offen offset:2048 sc1
    buffer_load_dwordx4 v[72:75], v25, s[48:51], s17 offen offset:2048 sc1
    buffer_load_dwordx4 v[76:79], v24, s[48:51], s30 offen offset:1024 sc1
    buffer_load_dwordx4 v[80:83], v25, s[48:51], s30 offen offset:1024 sc1
    s_waitcnt vmcnt(10)
    v_max3_u32 v2, v92, v93, v94
    v_max3_u32 v2, v2, v95, v96
    v_max3_u32 v2, v2, v97, v98
    v_max_u32 v2, v2, v99
    v_cmp_eq_u32 vcc, -1, v2
    s_cbranch_vccnz Lact_6
    s_branch Lactb_6
Lact_7:
    s_add_u32 s88, s88, 1
    s_cmp_gt_u32 s88, 32768
    s_cbranch_scc1 Lactb_7
    buffer_load_dwordx4 v[40:43], v24, s[48:51], 0 offen offset:1024 sc1
    buffer_load_dwordx4 v[44:47], v25, s[48:51], 0 offen offset:1024 sc1
    buffer_load_dwordx4 v[48:51], v24, s[48:51], s16 offen offset:0 sc1
    buffer_load_dwordx4 v[52:55], v25, s[48:51], s16 offen offset:0 sc1
    buffer_load_dwordx4 v[56:59], v24, s[48:51], s16 offen offset:3072 sc1
    buffer_load_dwordx4 v[60:63], v25, s[48:51], s16 offen offset:3072 sc1
    buffer_load_dwordx4 v[64:67], v24, s[48:51], s17 offen offset:2048 sc1
    buffer_load_dwordx4 v[72:75], v25, s[48:51], s17 offen offset:2048 sc1
    buffer_load_dwordx4 v[76:79], v24, s[48:51], s30 offen offset:1024 sc1
    buffer_load_dwordx4 v[80:83], v25, s[48:51], s30 offen offset:1024 sc1
    buffer_load_dwordx4 v[84:87], v24, s[48:51], s31 offen offset:0 sc1
    buffer_load_dwordx4 v[88:91], v25, s[48:51], s31 offen offset:0 sc1
    s_waitcnt vmcnt(10)
    v_max3_u32 v2, v40, v41, v42
    v_max3_u32 v2, v2, v43, v44
    v_max3_u32 v2, v2, v45, v46
    v_max_u32 v2, v2, v47
    v_cmp_eq_u32 vcc, -1, v2
    s_cbranch_vccnz Lact_7
    s_branch Lactb_7
Lact_8:
    s_add_u32 s88, s88, 1
    s_cmp_gt_u32 s88, 32768
    s_cbranch_scc1 Lactb_8
    buffer_load_dwordx4 v[48:51], v24, s[48:51], s16 offen offset:0 sc1
    buffer_load_dwordx4 v[52:55], v25, s[48:51], s16 offen offset:0 sc1
    buffer_load_dwordx4 v[56:59], v24, s[48:51], s16 offen offset:3072 sc1
    buffer_load_dwordx4 v[60:63], v25, s[48:51], s16 offen offset:3072 sc1
    buffer_load_dwordx4 v[64:67], v24, s[48:51], s17 offen offset:2048 sc1
    buffer_load_dwordx4 v[72:75], v25, s[48:51], s17 offen offset:2048 sc1
    buffer_load_dwordx4 v[76:79], v24, s[48:51], s30 offen offset:1024 sc1
    buffer_load_dwordx4 v[80:83], v25, s[48:51], s30 offen offset:1024 sc1
    buffer_load_dwordx4 v[84:87], v24, s[48:51], s31 offen offset:0 sc1
    buffer_load_dwordx4 v[88:91], v25, s[48:51], s31 offen offset:0 sc1
    buffer_load_dwordx4 v[92:95], v24, s[48:51], s31 offen offset:3072 sc1
    buffer_load_dwordx4 v[96:99], v25, s[48:51], s31 offen offset:3072 sc1
    s_waitcnt vmcnt(10)
    v_max3_u32 v2, v48, v49, v50
    v_max3_u32 v2, v2, v51, v52
    v_max3_u32 v2, v2, v53, v54
    v_max_u32 v2, v2, v55
    v_cmp_eq_u32 vcc, -1, v2
    s_cbranch_vccnz Lact_8
    s_branch Lactb_8
Lact_9:
    s_add_u32 s88, s88, 1
    s_cmp_gt_u32 s88, 32768
    s_cbranch_scc1 Lactb_9
    buffer_load_dwordx4 v[56:59], v24, s[48:51], s16 offen offset:3072 sc1
    buffer_load_dwordx4 v[60:63], v25, s[48:51], s16 offen offset:3072 sc1
    buffer_load_dwordx4 v[64:67], v24, s[48:51], s17 offen offset:2048 sc1
    buffer_load_dwordx4 v[72:75], v25, s[48:51], s17 offen offset:2048 sc1
    buffer_load_dwordx4 v[76:79], v24, s[48:51], s30 offen offset:1024 sc1
    buffer_load_dwordx4 v[80:83], v25, s[48:51], s30 offen offset:1024 sc1
    buffer_load_dwordx4 v[84:87], v24, s[48:51], s31 offen offset:0 sc1
    buffer_load_dwordx4 v[88:91], v25, s[48:51], s31 offen offset:0 sc1
    buffer_load_dwordx4 v[92:95], v24, s[48:51], s31 offen offset:3072 sc1
    buffer_load_dwordx4 v[96:99], v25, s[48:51], s31 offen offset:3072 sc1
    buffer_load_dwordx4 v[40:43], v24, s[48:51], 0 offen offset:2048 sc1
    buffer_load_dwordx4 v[44:47], v25, s[48:51], 0 offen offset:2048 sc1
    s_waitcnt vmcnt(10)
    v_max3_u32 v2, v56, v57, v58
    v_max3_u32 v2, v2, v59, v60
    v_max3_u32 v2, v2, v61, v62
    v_max_u32 v2, v2, v63
    v_cmp_eq_u32 vcc, -1, v2
    s_cbranch_vccnz Lact_9
    s_branch Lactb_9
Lact_10:
    s_add_u32 s88, s88, 1
    s_cmp_gt_u32 s88, 32768
    s_cbranch_scc1 Lactb_10
    buffer_load_dwordx4 v[64:67], v24, s[48:51], s17 offen offset:2048 sc1
    buffer_load_dwordx4 v[72:75], v25, s[48:51], s17 offen offset:2048 sc1
    buffer_load_dwordx4 v[76:79], v24, s[48:51], s30 offen offset:1024 sc1
    buffer_load_dwordx4 v[80:83], v25, s[48:51], s30 offen offset:1024 sc1
    buffer_load_dwordx4 v[84:87], v24, s[48:51], s31 offen offset:0 sc1
    buffer_load_dwordx4 v[88:91], v25, s[48:51], s31 offen offset:0 sc1
    buffer_load_dwordx4 v[92:95], v24, s[48:51], s31 offen offset:3072 sc1
    buffer_load_dwordx4 v[96:99], v25, s[48:51], s31 offen offset:3072 sc1
    buffer_load_dwordx4 v[40:43], v24, s[48:51], 0 offen offset:2048 sc1
    buffer_load_dwordx4 v[44:47], v25, s[48:51], 0 offen offset:2048 sc1
    buffer_load_dwordx4 v[48:51], v24, s[48:51], s16 offen offset:1024 sc1
    buffer_load_dwordx4 v[52:55], v25, s[48:51], s16 offen offset:1024 sc1
    s_waitcnt vmcnt(10)
    v_max3_u32 v2, v64, v65, v66
    v_max3_u32 v2, v2, v67, v72
    v_max3_u32 v2, v2, v73, v74
    v_max_u32 v2, v2, v75
    v_cmp_eq_u32 vcc, -1, v2
    s_cbranch_vccnz Lact_10
    s_branch Lactb_10
Lact_11:
    s_add_u32 s88, s88, 1
    s_cmp_gt_u32 s88, 32768
    s_cbranch_scc1 Lactb_11
    buffer_load_dwordx4 v[76:79], v24, s[48:51], s30 offen offset:1024 sc1
    buffer_load_dwordx4 v[80:83], v25, s[48:51], s30 offen offset:1024 sc1
    buffer_load_dwordx4 v[84:87], v24, s[48:51], s31 offen offset:0 sc1
    buffer_load_dwordx4 v[88:91], v25, s[48:51], s31 offen offset:0 sc1
    buffer_load_dwordx4 v[92:95], v24, s[48:51], s31 offen offset:3072 sc1
    buffer_load_dwordx4 v[96:99], v25, s[48:51], s31 offen offset:3072 sc1
    buffer_load_dwordx4 v[40:43], v24, s[48:51], 0 offen offset:2048 sc1
    buffer_load_dwordx4 v[44:47], v25, s[48:51], 0 offen offset:2048 sc1
    buffer_load_dwordx4 v[48:51], v24, s[48:51], s16 offen offset:1024 sc1
    buffer_load_dwordx4 v[52:55], v25, s[48:51], s16 offen offset:1024 sc1
    buffer_load_dwordx4 v[56:59], v24, s[48:51], s17 offen offset:0 sc1
    buffer_load_dwordx4 v[60:63], v25, s[48:51], s17 offen offset:0 sc1
    s_waitcnt vmcnt(10)
    v_max3_u32 v2, v76, v77, v78
    v_max3_u32 v2, v2, v79, v80
    v_max3_u32 v2, v2, v81, v82
    v_max_u32 v2, v2, v83
    v_cmp_eq_u32 vcc, -1, v2
    s_cbranch_vccnz Lact_11
    s_branch Lactb_11
Lact_12:
    s_add_u32 s88, s88, 1
    s_cmp_gt_u32 s88, 32768
    s_cbranch_scc1 Lactb_12
    buffer_load_dwordx4 v[84:87], v24, s[48:51], s31 offen offset:0 sc1
    buffer_load_dwordx4 v[88:91], v25, s[48:51], s31 offen offset:0 sc1
    buffer_load_dwordx4 v[92:95], v24, s[48:51], s31 offen offset:3072 sc1
    buffer_load_dwordx4 v[96:99], v25, s[48:51], s31 offen offset:3072 sc1
    buffer_load_dwordx4 v[40:43], v24, s[48:51], 0 offen offset:2048 sc1
    buffer_load_dwordx4 v[44:47], v25, s[48:51], 0 offen offset:2048 sc1
    buffer_load_dwordx4 v[48:51], v24, s[48:51], s16 offen offset:1024 sc1
    buffer_load_dwordx4 v[52:55], v25, s[48:51], s16 offen offset:1024 sc1
    buffer_load_dwordx4 v[56:59], v24, s[48:51], s17 offen offset:0 sc1
    buffer_load_dwordx4 v[60:63], v25, s[48:51], s17 offen offset:0 sc1
    buffer_load_dwordx4 v[64:67], v24, s[48:51], s17 offen offset:3072 sc1
    buffer_load_dwordx4 v[72:75], v25, s[48:51], s17 offen offset:3072 sc1
    s_waitcnt vmcnt(10)
    v_max3_u32 v2, v84, v85, v86
    v_max3_u32 v2, v2, v87, v88
    v_max3_u32 v2, v2, v89, v90
    v_max_u32 v2, v2, v91
    v_cmp_eq_u32 vcc, -1, v2
    s_cbranch_vccnz Lact_12
    s_branch Lactb_12
Lact_13:
    s_add_u32 s88, s88, 1
    s_cmp_gt_u32 s88, 32768
    s_cbranch_scc1 Lactb_13
    buffer_load_dwordx4 v[92:95], v24, s[48:51], s31 offen offset:3072 sc1
    buffer_load_dwordx4 v[96:99], v25, s[48:51], s31 offen offset:3072 sc1
    buffer_load_dwordx4 v[40:43], v24, s[48:51], 0 offen offset:2048 sc1
    buffer_load_dwordx4 v[44:47], v25, s[48:51], 0 offen offset:2048 sc1
    buffer_load_dwordx4 v[48:51], v24, s[48:51], s16 offen offset:1024 sc1
    buffer_load_dwordx4 v[52:55], v25, s[48:51], s16 offen offset:1024 sc1
    buffer_load_dwordx4 v[56:59], v24, s[48:51], s17 offen offset:0 sc1
    buffer_load_dwordx4 v[60:63], v25, s[48:51], s17 offen offset:0 sc1
    buffer_load_dwordx4 v[64:67], v24, s[48:51], s17 offen offset:3072 sc1
    buffer_load_dwordx4 v[72:75], v25, s[48:51], s17 offen offset:3072 sc1
    buffer_load_dwordx4 v[76:79], v24, s[48:51], s30 offen offset:2048 sc1
    buffer_load_dwordx4 v[80:83], v25, s[48:51], s30 offen offset:2048 sc1
    s_waitcnt vmcnt(10)
    v_max3_u32 v2, v92, v93, v94
    v_max3_u32 v2, v2, v95, v96
    v_max3_u32 v2, v2, v97, v98
    v_max_u32 v2, v2, v99
    v_cmp_eq_u32 vcc, -1, v2
    s_cbranch_vccnz Lact_13
    s_branch Lactb_13
Lact_14:
    s_add_u32 s88, s88, 1
    s_cmp_gt_u32 s88, 32768
    s_cbranch_scc1 Lactb_14
    buffer_load_dwordx4 v[40:43], v24, s[48:51], 0 offen offset:2048 sc1
    buffer_load_dwordx4 v[44:47], v25, s[48:51], 0 offen offset:2048 sc1
    buffer_load_dwordx4 v[48:51], v24, s[48:51], s16 offen offset:1024 sc1
    buffer_load_dwordx4 v[52:55], v25, s[48:51], s16 offen offset:1024 sc1
    buffer_load_dwordx4 v[56:59], v24, s[48:51], s17 offen offset:0 sc1
    buffer_load_dwordx4 v[60:63], v25, s[48:51], s17 offen offset:0 sc1
    buffer_load_dwordx4 v[64:67], v24, s[48:51], s17 offen offset:3072 sc1
    buffer_load_dwordx4 v[72:75], v25, s[48:51], s17 offen offset:3072 sc1
    buffer_load_dwordx4 v[76:79], v24, s[48:51], s30 offen offset:2048 sc1
    buffer_load_dwordx4 v[80:83], v25, s[48:51], s30 offen offset:2048 sc1
    buffer_load_dwordx4 v[84:87], v24, s[48:51], s31 offen offset:1024 sc1
    buffer_load_dwordx4 v[88:91], v25, s[48:51], s31 offen offset:1024 sc1
    s_waitcnt vmcnt(10)
    v_max3_u32 v2, v40, v41, v42
    v_max3_u32 v2, v2, v43, v44
    v_max3_u32 v2, v2, v45, v46
    v_max_u32 v2, v2, v47
    v_cmp_eq_u32 vcc, -1, v2
    s_cbranch_vccnz Lact_14
    s_branch Lactb_14
Lact_15:
    s_add_u32 s88, s88, 1
    s_cmp_gt_u32 s88, 32768
    s_cbranch_scc1 Lactb_15
    buffer_load_dwordx4 v[48:51], v24, s[48:51], s16 offen offset:1024 sc1
    buffer_load_dwordx4 v[52:55], v25, s[48:51], s16 offen offset:1024 sc1
    buffer_load_dwordx4 v[56:59], v24, s[48:51], s17 offen offset:0 sc1
    buffer_load_dwordx4 v[60:63], v25, s[48:51], s17 offen offset:0 sc1
    buffer_load_dwordx4 v[64:67], v24, s[48:51], s17 offen offset:3072 sc1
    buffer_load_dwordx4 v[72:75], v25, s[48:51], s17 offen offset:3072 sc1
    buffer_load_dwordx4 v[76:79], v24, s[48:51], s30 offen offset:2048 sc1
    buffer_load_dwordx4 v[80:83], v25, s[48:51], s30 offen offset:2048 sc1
    buffer_load_dwordx4 v[84:87], v24, s[48:51], s31 offen offset:1024 sc1
    buffer_load_dwordx4 v[88:91], v25, s[48:51], s31 offen offset:1024 sc1
    buffer_load_dwordx4 v[92:95], v24, s[48:51], s32 offen offset:0 sc1
    buffer_load_dwordx4 v[96:99], v25, s[48:51], s32 offen offset:0 sc1
    s_waitcnt vmcnt(10)
    v_max3_u32 v2, v48, v49, v50
    v_max3_u32 v2, v2, v51, v52
    v_max3_u32 v2, v2, v53, v54
    v_max_u32 v2, v2, v55
    v_cmp_eq_u32 vcc, -1, v2
    s_cbranch_vccnz Lact_15
    s_branch Lactb_15
Lact_16:
    s_add_u32 s88, s88, 1
    s_cmp_gt_u32 s88, 32768
    s_cbranch_scc1 Lactb_16
    buffer_load_dwordx4 v[56:59], v24, s[48:51], s17 offen offset:0 sc1
    buffer_load_dwordx4 v[60:63], v25, s[48:51], s17 offen offset:0 sc1
    buffer_load_dwordx4 v[64:67], v24, s[48:51], s17 offen offset:3072 sc1
    buffer_load_dwordx4 v[72:75], v25, s[48:51], s17 offen offset:3072 sc1
    buffer_load_dwordx4 v[76:79], v24, s[48:51], s30 offen offset:2048 sc1
    buffer_load_dwordx4 v[80:83], v25, s[48:51], s30 offen offset:2048 sc1
    buffer_load_dwordx4 v[84:87], v24, s[48:51], s31 offen offset:1024 sc1
    buffer_load_dwordx4 v[88:91], v25, s[48:51], s31 offen offset:1024 sc1
    buffer_load_dwordx4 v[92:95], v24, s[48:51], s32 offen offset:0 sc1
    buffer_load_dwordx4 v[96:99], v25, s[48:51], s32 offen offset:0 sc1
    buffer_load_dwordx4 v[40:43], v26, s[48:51], 0 offen sc1
    buffer_load_dwordx4 v[44:47], v27, s[48:51], 0 offen sc1
    s_waitcnt vmcnt(10)
    v_max3_u32 v2, v56, v57, v58
    v_max3_u32 v2, v2, v59, v60
    v_max3_u32 v2, v2, v61, v62
    v_max_u32 v2, v2, v63
    v_cmp_eq_u32 vcc, -1, v2
    s_cbranch_vccnz Lact_16
    s_branch Lactb_16
Lact_17:
    s_add_u32 s88, s88, 1
    s_cmp_gt_u32 s88, 32768
    s_cbranch_scc1 Lactb_17
    buffer_load_dwordx4 v[64:67], v24, s[48:51], s17 offen offset:3072 sc1
    buffer_load_dwordx4 v[72:75], v25, s[48:51], s17 offen offset:3072 sc1
    buffer_load_dwordx4 v[76:79], v24, s[48:51], s30 offen offset:2048 sc1
    buffer_load_dwordx4 v[80:83], v25, s[48:51], s30 offen offset:2048 sc1
    buffer_load_dwordx4 v[84:87], v24, s[48:51], s31 offen offset:1024 sc1
    buffer_load_dwordx4 v[88:91], v25, s[48:51], s31 offen offset:1024 sc1
    buffer_load_dwordx4 v[92:95], v24, s[48:51], s32 offen offset:0 sc1
    buffer_load_dwordx4 v[96:99], v25, s[48:51], s32 offen offset:0 sc1
    buffer_load_dwordx4 v[40:43], v26, s[48:51], 0 offen sc1
    buffer_load_dwordx4 v[44:47], v27, s[48:51], 0 offen sc1
    s_waitcnt vmcnt(8)
    v_max3_u32 v2, v64, v65, v66
    v_max3_u32 v2, v2, v67, v72
    v_max3_u32 v2, v2, v73, v74
    v_max_u32 v2, v2, v75
    v_cmp_eq_u32 vcc, -1, v2
    s_cbranch_vccnz Lact_17
    s_branch Lactb_17
Lact_18:
    s_add_u32 s88, s88, 1
    s_cmp_gt_u32 s88, 32768
    s_cbranch_scc1 Lactb_18
    buffer_load_dwordx4 v[76:79], v24, s[48:51], s30 offen offset:2048 sc1
    buffer_load_dwordx4 v[80:83], v25, s[48:51], s30 offen offset:2048 sc1
    buffer_load_dwordx4 v[84:87], v24, s[48:51], s31 offen offset:1024 sc1
    buffer_load_dwordx4 v[88:91], v25, s[48:51], s31 offen offset:1024 sc1
    buffer_load_dwordx4 v[92:95], v24, s[48:51], s32 offen offset:0 sc1
    buffer_load_dwordx4 v[96:99], v25, s[48:51], s32 offen offset:0 sc1
    buffer_load_dwordx4 v[40:43], v26, s[48:51], 0 offen sc1
    buffer_load_dwordx4 v[44:47], v27, s[48:51], 0 offen sc1
    s_waitcnt vmcnt(6)
    v_max3_u32 v2, v76, v77, v78
    v_max3_u32 v2, v2, v79, v80
    v_max3_u32 v2, v2, v81, v82
    v_max_u32 v2, v2, v83
    v_cmp_eq_u32 vcc, -1, v2
    s_cbranch_vccnz Lact_18
    s_branch Lactb_18
Lact_19:
    s_add_u32 s88, s88, 1
    s_cmp_gt_u32 s88, 32768
    s_cbranch_scc1 Lactb_19
    buffer_load_dwordx4 v[84:87], v24, s[48:51], s31 offen offset:1024 sc1
    buffer_load_dwordx4 v[88:91], v25, s[48:51], s31 offen offset:1024 sc1
    buffer_load_dwordx4 v[92:95], v24, s[48:51], s32 offen offset:0 sc1
    buffer_load_dwordx4 v[96:99], v25, s[48:51], s32 offen offset:0 sc1
    buffer_load_dwordx4 v[40:43], v26, s[48:51], 0 offen sc1
    buffer_load_dwordx4 v[44:47], v27, s[48:51], 0 offen sc1
    s_waitcnt vmcnt(4)
    v_max3_u32 v2, v84, v85, v86
    v_max3_u32 v2, v2, v87, v88
    v_max3_u32 v2, v2, v89, v90
    v_max_u32 v2, v2, v91
    v_cmp_eq_u32 vcc, -1, v2
    s_cbranch_vccnz Lact_19
    s_branch Lactb_19
Lact_20:
    s_add_u32 s88, s88, 1
    s_cmp_gt_u32 s88, 32768
    s_cbranch_scc1 Lactb_20
    buffer_load_dwordx4 v[92:95], v24, s[48:51], s32 offen offset:0 sc1
    buffer_load_dwordx4 v[96:99], v25, s[48:51], s32 offen offset:0 sc1
    buffer_load_dwordx4 v[40:43], v26, s[48:51], 0 offen sc1
    buffer_load_dwordx4 v[44:47], v27, s[48:51], 0 offen sc1
    s_waitcnt vmcnt(2)
    v_max3_u32 v2, v92, v93, v94
    v_max3_u32 v2, v2, v95, v96
    v_max3_u32 v2, v2, v97, v98
    v_max_u32 v2, v2, v99
    v_cmp_eq_u32 vcc, -1, v2
    s_cbranch_vccnz Lact_20
    s_branch Lactb_20
Lact_21:
    s_add_u32 s88, s88, 1
    s_cmp_gt_u32 s88, 32768
    s_cbranch_scc1 Lactb_21
    buffer_load_dwordx4 v[40:43], v26, s[48:51], 0 offen sc1
    buffer_load_dwordx4 v[44:47], v27, s[48:51], 0 offen sc1
    s_waitcnt vmcnt(0)
    v_max3_u32 v2, v40, v41, v42
    v_max3_u32 v2, v2, v43, v44
    v_max3_u32 v2, v2, v45, v46
    v_max_u32 v2, v2, v47
    v_cmp_eq_u32 vcc, -1, v2
    s_cbranch_vccnz Lact_21
    s_branch Lactb_21
.p2align 12
L_codeend:

.section .rodata,"a"
.p2align 6
.amdhsa_kernel adaLN_cond__ssm_conv_s4d__geglu_ffn__prompt_kernel
  .amdhsa_next_free_vgpr 512
  .amdhsa_next_free_sgpr 102
  .amdhsa_accum_offset 256
  .amdhsa_group_segment_fixed_size 0
  .amdhsa_kernarg_size 128
  .amdhsa_user_sgpr_count 2
  .amdhsa_user_sgpr_kernarg_segment_ptr 1
  .amdhsa_system_sgpr_workgroup_id_x 1
.end_amdhsa_kernel
```
